```python
import torch

def _softmax(x, axis=-1):
    return torch.softmax(x, dim=axis)
def _gelu(x):
    return torch.nn.functional.gelu(x, approximate="tanh")
def _silu(x):
    return torch.nn.functional.silu(x)
def _sigmoid(x):
    return torch.sigmoid(x)
def _layernorm(x, axis=-1, eps=1e-5):
    m = x.mean(dim=axis, keepdim=True)
    v = x.var(dim=axis, keepdim=True, unbiased=False)
    return (x - m) / torch.sqrt(v + eps)
def _scatter_add(tgt, idx, src, axis=0):
    return tgt.clone().index_add_(axis, idx, src)
def _segment_sum(src, seg, n):
    out = torch.zeros((n,) + src.shape[1:], dtype=src.dtype)
    return out.index_add_(0, seg, src)
def _pad(x, pw):
    flat = tuple(v for pair in reversed(pw) for v in pair)
    return torch.nn.functional.pad(x, flat)

kernel_name = 'concat_heads__mha_block_cached__gqa_block_cached__near_ridge'

def setup_inputs():

    _w = (lambda a: (lambda t: t.to(torch.bfloat16) if t.is_floating_point() else t)(torch.as_tensor(a)))
    def _A_setup():
        B, Sq, D = 16, 64, 576
        H, Sk, Dh = 32, 64, 128
        return {
            "x": _w((lambda *s: torch.randn(*s, dtype=torch.bfloat16) * 0.8)(B, Sq, D)),
            "k_cache": _w((lambda *s: torch.randn(*s, dtype=torch.bfloat16) * 0.8)(B, H, Sk, Dh)),
            "v_cache": _w((lambda *s: torch.randn(*s, dtype=torch.bfloat16) * 0.05)(B, H, Sk, Dh)),
            "wq": _w((lambda *s: torch.randn(*s, dtype=torch.bfloat16) * 0.8)(D, H * Dh) * (D ** -0.5)),
            "wo": _w((lambda *s: torch.randn(*s, dtype=torch.bfloat16) * 0.05)(H * Dh, D) * ((H * Dh) ** -0.5)),
        }
    _A_in = _A_setup()

    def _B_setup():
        B, Sq, D = 16, 64, 576
        Hq, Hkv, Sk, Dh = 32, 32, 64, 128
        assert Hq % Hkv == 0, (Hq, Hkv)
        return {
            "x": _w((lambda *s: torch.randn(*s, dtype=torch.bfloat16) * 0.8)(B, Sq, D)),
            "k_cache": _w((lambda *s: torch.randn(*s, dtype=torch.bfloat16) * 0.8)(B, Hkv, Sk, Dh)),
            "v_cache": _w((lambda *s: torch.randn(*s, dtype=torch.bfloat16) * 0.05)(B, Hkv, Sk, Dh)),
            "wq": _w((lambda *s: torch.randn(*s, dtype=torch.bfloat16) * 0.8)(D, Hq * Dh) * (D ** -0.5)),
            "wo": _w((lambda *s: torch.randn(*s, dtype=torch.bfloat16) * 0.05)(Hq * Dh, D) * ((Hq * Dh) ** -0.5)),
        }
    _B_in = _B_setup()

    return {
        "A_x": _A_in["x"],
        "A_k_cache": _A_in["k_cache"],
        "A_v_cache": _A_in["v_cache"],
        "A_wq": _A_in["wq"],
        "A_wo": _A_in["wo"],
        "B_x": _B_in["x"],
        "B_k_cache": _B_in["k_cache"],
        "B_v_cache": _B_in["v_cache"],
        "B_wq": _B_in["wq"],
        "B_wo": _B_in["wo"],
    }

def reference(A_x, A_k_cache, A_v_cache, A_wq, A_wo, B_x, B_k_cache, B_v_cache, B_wq, B_wo):
    def _A_ref(x, k_cache, v_cache, wq, wo):
        B, Sq, D = x.shape
        H, Dh = 32, 128
        q = (lambda x, *d: x.permute(*d))((x @ wq).reshape(B, Sq, H, Dh), 0, 2, 1, 3)
        scores = torch.einsum("bhqd,bhkd->bhqk", q, k_cache) * (Dh ** -0.5)
        p = _softmax(scores, axis=-1)
        o = torch.einsum("bhqk,bhkd->bhqd", p, v_cache)
        return (lambda x, *d: x.permute(*d))(o, 0, 2, 1, 3).reshape(B, Sq, H * Dh) @ wo

    def _B_ref(x, k_cache, v_cache, wq, wo):
        B, Sq, D = x.shape
        Hq, Dh = 32, 128
        Hkv = k_cache.shape[1]
        rep = Hq // Hkv
        q = (lambda x, *d: x.permute(*d))((x @ wq).reshape(B, Sq, Hq, Dh), 0, 2, 1, 3)
        k = (lambda x, n, axis: torch.repeat_interleave(x, n, dim=axis))(k_cache, rep, axis=1)
        v = (lambda x, n, axis: torch.repeat_interleave(x, n, dim=axis))(v_cache, rep, axis=1)
        scores = torch.einsum("bhqd,bhkd->bhqk", q, k) * (Dh ** -0.5)
        p = _softmax(scores, axis=-1)
        o = torch.einsum("bhqk,bhkd->bhqd", p, v)
        return (lambda x, *d: x.permute(*d))(o, 0, 2, 1, 3).reshape(B, Sq, Hq * Dh) @ wo

    a = _A_ref(A_x, A_k_cache, A_v_cache, A_wq, A_wo)
    b = _B_ref(B_x, B_k_cache, B_v_cache, B_wq, B_wo)
    return torch.concatenate([a, b], axis=-1)
```

```asm
; @launch grid=(256,1,1) block=(512,1,1) lds=163840
.amdgcn_target "amdgcn-amd-amdhsa--gfx950"
.text
.globl concat_heads__mha_block_cached__gqa_block_cached__near_ridge_kernel
.p2align 8
.type concat_heads__mha_block_cached__gqa_block_cached__near_ridge_kernel,@function
concat_heads__mha_block_cached__gqa_block_cached__near_ridge_kernel:
    s_cmp_ge_u32 s2, 256
    s_cbranch_scc1 L_end
    s_bfe_u32 s30, s2, 0x10002
    s_mul_i32 s52, s30, 40
    s_load_dwordx8 s[4:11], s[0:1], s52
    s_add_u32 s53, s52, 32
    s_load_dwordx2 s[12:13], s[0:1], s53
    s_load_dwordx4 s[24:27], s[0:1], 80
    s_load_dwordx2 s[28:29], s[0:1], 96
    v_lshrrev_b32 v1, 6, v0
    v_and_b32 v0, 63, v0
    v_readfirstlane_b32 s3, v1
    s_and_b32 s51, s2, 3
    s_lshr_b32 s31, s2, 4
    s_bfe_u32 s54, s2, 0x10003
    s_lshl_b32 s51, s51, 1
    s_add_u32 s48, s51, s54
    s_mul_i32 s55, s31, 9
    s_lshr_b32 s14, s55, 4
    s_lshl_b32 s54, s54, 2
    s_add_u32 s49, s14, s54
    s_and_b32 s54, s2, 3
    s_mul_i32 s54, s54, 1
    s_add_u32 s49, s49, s54
    s_cmp_ge_u32 s49, 18
    s_cselect_b32 s54, 9, 0
    s_sub_u32 s49, s49, s54
    s_cmp_ge_u32 s49, 9
    s_cselect_b32 s54, 9, 0
    s_sub_u32 s49, s49, s54
    s_lshl_b32 s50, s30, 4
    s_add_u32 s50, s50, s31
    s_cmp_lt_u32 s3, 4
    s_cbranch_scc1 L_compute
    s_sub_u32 s51, s3, 4
    v_lshrrev_b32 v12, 3, v0
    v_mul_u32_u24 v12, 1152, v12
    v_lshrrev_b32 v13, 4, v0
    v_and_b32 v14, 7, v0
    v_xor_b32 v14, v14, v13
    v_lshl_add_u32 v5, v14, 4, v12
    v_xor_b32 v14, 4, v14
    v_lshl_add_u32 v6, v14, 4, v12
    v_add_u32 v6, 8192, v6
    s_lshl_b32 s53, s51, 12
    s_lshl_b32 s59, s51, 11
    s_mul_i32 s54, s51, 18432
    s_lshl_b32 s55, s49, 7
    s_add_u32 s54, s54, s55
    s_mov_b32 s55, s49
    s_lshl_b32 s57, s49, 19
    s_lshl_b32 s56, s51, 15
    s_add_u32 s57, s57, s56
    s_and_b32 s56, s51, 1
    s_lshl_b32 s56, s56, 3
    v_xor_b32 v10, s56, v0
    v_mul_u32_u24 v11, 1792, v13
    v_xor_b32 v1, 0, v10
    v_lshl_add_u32 v1, v1, 4, v11
    v_xor_b32 v2, 2, v10
    v_lshl_add_u32 v2, v2, 4, v11
    v_add_u32 v2, 7168, v2
    v_xor_b32 v3, 4, v10
    v_lshl_add_u32 v3, v3, 4, v11
    v_add_u32 v3, 14336, v3
    v_xor_b32 v4, 6, v10
    v_lshl_add_u32 v4, v4, 4, v11
    v_add_u32 v4, 21504, v4
    s_mul_i32 s44, s31, 73728
    s_lshl_b32 s45, s48, 8
    s_sub_u32 s38, 4718592, s45
    s_mov_b32 s39, 0x20000
    s_mov_b32 s34, 73728
    s_mov_b32 s35, 0x20000
    s_waitcnt lgkmcnt(0)
    s_add_u32 s32, s4, s44
    s_addc_u32 s33, s5, 0
    s_add_u32 s36, s10, s45
    s_addc_u32 s37, s11, 0
    s_add_u32 m0, s59, 90112
    s_add_u32 s55, s55, 1
    buffer_load_dwordx4 v5, s[32:35], s54 offen offset:0 lds
    buffer_load_dwordx4 v6, s[32:35], s54 offen offset:1024 lds
    s_add_u32 s54, s54, 128
    s_cmp_eq_u32 s55, 9
    s_cselect_b32 s55, 0, s55
    s_cselect_b32 s58, 1152, 0
    s_sub_u32 s54, s54, s58
    s_add_u32 m0, s53, 0
    s_nop 0
    buffer_load_dwordx4 v1, s[36:39], s57 offen offset:0 lds
    buffer_load_dwordx4 v2, s[36:39], s57 offen offset:1024 lds
    buffer_load_dwordx4 v3, s[36:39], s57 offen offset:2048 lds
    buffer_load_dwordx4 v4, s[36:39], s57 offen offset:3072 lds
    s_add_u32 s57, s57, 131072
    s_add_u32 m0, s53, 16384
    s_nop 0
    buffer_load_dwordx4 v1, s[36:39], s57 offen offset:0 lds
    buffer_load_dwordx4 v2, s[36:39], s57 offen offset:1024 lds
    buffer_load_dwordx4 v3, s[36:39], s57 offen offset:2048 lds
    buffer_load_dwordx4 v4, s[36:39], s57 offen offset:3072 lds
    s_add_u32 s57, s57, 131072
    s_getpc_b64 s[62:63]
L_pc:
    s_lshr_b32 s52, s2, 3
    s_lshl_b32 s52, s52, 2
    s_add_u32 s52, s52, s51
    s_mul_i32 s52, s52, 192
    s_min_u32 s52, s52, L_end - L_att - 192
    s_add_u32 s52, s52, L_att - L_pc
    s_add_u32 s62, s62, s52
    s_addc_u32 s63, s63, 0
    s_load_dword s100, s[62:63], 0
    s_load_dword s101, s[62:63], 64
    s_load_dword s100, s[62:63], 128
    s_lshl_b32 s52, s31, 5
    s_add_u32 s52, s52, s48
    s_lshl_b32 s52, s52, 14
    s_add_u32 s40, s6, s52
    s_addc_u32 s41, s7, 0
    s_mov_b32 s42, 409600
    s_mov_b32 s43, 0x20000
    s_add_u32 s44, s8, s52
    s_addc_u32 s45, s9, 0
    s_mov_b32 s46, 409600
    s_mov_b32 s47, 0x20000
    s_and_b32 s52, s51, 1
    s_lshl_b32 s52, s52, 3
    v_lshlrev_b32 v12, 8, v13
    v_and_b32 v14, 15, v0
    v_xor_b32 v15, v14, v13
    v_xor_b32 v15, s52, v15
    v_lshl_add_u32 v7, v15, 4, v12
    v_xor_b32 v15, 4, v15
    v_lshl_add_u32 v8, v15, 4, v12
    v_lshlrev_b32 v16, 1, v13
    v_xor_b32 v16, v16, v14
    v_lshl_add_u32 v9, v16, 4, v12
    v_xor_b32 v16, 8, v16
    v_lshl_add_u32 v10, v16, 4, v12
    s_mul_i32 s52, s48, 147456
    s_add_u32 s60, s12, s52
    s_addc_u32 s61, s13, 0
    s_mov_b32 s62, 3686400
    s_mov_b32 s63, 0x20000
    v_lshrrev_b32 v12, 3, v0
    v_mul_u32_u24 v12, 1152, v12
    v_lshlrev_b32 v14, 1, v13
    v_and_b32 v15, 7, v0
    v_xor_b32 v14, v14, v15
    v_lshl_add_u32 v16, v14, 4, v12
    v_add_u32 v17, 8192, v16
    v_add_u32 v18, 16384, v16
    v_add_u32 v19, 24576, v16
    s_lshl_b32 s52, s50, 12
    s_add_u32 s52, s52, 25165824
    s_add_u32 s16, s28, s52
    s_addc_u32 s17, s29, 0
    s_mov_b32 s18, 4096
    s_mov_b32 s19, 0x20000
    s_mov_b32 s20, s26
    s_mov_b32 s21, s27
    s_mov_b32 s22, 256
    s_mov_b32 s23, 0x20000
    s_lshl_b32 s52, s50, 2
    v_mov_b32 v72, s52
    s_add_u32 s56, s48, s51
    s_cmp_eq_u32 s56, 0
    s_cselect_b32 s98, 4096, 0
    s_mov_b32 s96, s16
    s_mov_b32 s97, s17
    s_mov_b32 s99, 0x20000
    v_mov_b32 v32, 0
    v_mov_b32 v33, 0
    v_mov_b32 v34, 0
    v_mov_b32 v35, 0
    v_lshlrev_b32 v36, 4, v0
    v_mov_b32 v31, 1
    buffer_store_dwordx4 v[32:35], v36, s[96:99], 0 offen sc1
    buffer_store_dwordx4 v[32:35], v36, s[96:99], 0 offen offset:1024 sc1
    s_waitcnt vmcnt(6)
    s_barrier
    s_add_u32 m0, s53, 32768
    s_nop 0
    buffer_load_dwordx4 v1, s[36:39], s57 offen offset:0 lds
    buffer_load_dwordx4 v2, s[36:39], s57 offen offset:1024 lds
    buffer_load_dwordx4 v3, s[36:39], s57 offen offset:2048 lds
    buffer_load_dwordx4 v4, s[36:39], s57 offen offset:3072 lds
    s_add_u32 s57, s57, 131072
    s_add_u32 m0, s53, 49152
    s_nop 0
    buffer_load_dwordx4 v1, s[36:39], s57 offen offset:0 lds
    buffer_load_dwordx4 v2, s[36:39], s57 offen offset:1024 lds
    buffer_load_dwordx4 v3, s[36:39], s57 offen offset:2048 lds
    buffer_load_dwordx4 v4, s[36:39], s57 offen offset:3072 lds
    s_add_u32 s57, s57, 131072
    s_cmp_ge_u32 s57, 4718592
    s_cselect_b32 s58, 4718592, 0
    s_sub_u32 s57, s57, s58
    s_waitcnt vmcnt(10)
    s_barrier
    s_add_u32 m0, s53, 0
    s_nop 0
    buffer_load_dwordx4 v1, s[36:39], s57 offen offset:0 lds
    buffer_load_dwordx4 v2, s[36:39], s57 offen offset:1024 lds
    buffer_load_dwordx4 v3, s[36:39], s57 offen offset:2048 lds
    buffer_load_dwordx4 v4, s[36:39], s57 offen offset:3072 lds
    s_add_u32 s57, s57, 131072
    s_add_u32 m0, s59, 98304
    s_add_u32 s55, s55, 1
    buffer_load_dwordx4 v5, s[32:35], s54 offen offset:0 lds
    buffer_load_dwordx4 v6, s[32:35], s54 offen offset:1024 lds
    s_add_u32 s54, s54, 128
    s_cmp_eq_u32 s55, 9
    s_cselect_b32 s55, 0, s55
    s_cselect_b32 s58, 1152, 0
    s_sub_u32 s54, s54, s58
    s_waitcnt vmcnt(10)
    s_barrier
    s_add_u32 m0, s53, 16384
    s_nop 0
    buffer_load_dwordx4 v1, s[36:39], s57 offen offset:0 lds
    buffer_load_dwordx4 v2, s[36:39], s57 offen offset:1024 lds
    buffer_load_dwordx4 v3, s[36:39], s57 offen offset:2048 lds
    buffer_load_dwordx4 v4, s[36:39], s57 offen offset:3072 lds
    s_add_u32 s57, s57, 131072
    s_waitcnt vmcnt(10)
    s_barrier
    s_add_u32 m0, s53, 32768
    s_nop 0
    buffer_load_dwordx4 v1, s[36:39], s57 offen offset:0 lds
    buffer_load_dwordx4 v2, s[36:39], s57 offen offset:1024 lds
    buffer_load_dwordx4 v3, s[36:39], s57 offen offset:2048 lds
    buffer_load_dwordx4 v4, s[36:39], s57 offen offset:3072 lds
    s_add_u32 s57, s57, 131072
    s_waitcnt vmcnt(22)
    s_mov_b32 s96, s20
    s_mov_b32 s97, s21
    s_lshr_b32 s98, s98, 4
    buffer_store_dword v31, v72, s[96:99], 0 offen sc1
    s_waitcnt vmcnt(9)
    s_barrier
    s_add_u32 m0, s53, 49152
    s_nop 0
    buffer_load_dwordx4 v1, s[36:39], s57 offen offset:0 lds
    buffer_load_dwordx4 v2, s[36:39], s57 offen offset:1024 lds
    buffer_load_dwordx4 v3, s[36:39], s57 offen offset:2048 lds
    buffer_load_dwordx4 v4, s[36:39], s57 offen offset:3072 lds
    s_add_u32 s57, s57, 131072
    s_cmp_ge_u32 s57, 4718592
    s_cselect_b32 s58, 4718592, 0
    s_sub_u32 s57, s57, s58
    s_add_u32 m0, s59, 106496
    s_add_u32 s55, s55, 1
    buffer_load_dwordx4 v5, s[32:35], s54 offen offset:0 lds
    buffer_load_dwordx4 v6, s[32:35], s54 offen offset:1024 lds
    s_add_u32 s54, s54, 128
    s_cmp_eq_u32 s55, 9
    s_cselect_b32 s55, 0, s55
    s_cselect_b32 s58, 1152, 0
    s_sub_u32 s54, s54, s58
    s_add_u32 m0, s59, 114688
    s_add_u32 s55, s55, 1
    buffer_load_dwordx4 v5, s[32:35], s54 offen offset:0 lds
    buffer_load_dwordx4 v6, s[32:35], s54 offen offset:1024 lds
    s_add_u32 s54, s54, 128
    s_cmp_eq_u32 s55, 9
    s_cselect_b32 s55, 0, s55
    s_cselect_b32 s58, 1152, 0
    s_sub_u32 s54, s54, s58
    s_add_u32 m0, s59, 65536
    s_add_u32 s56, s59, 0
    buffer_load_dwordx4 v7, s[40:43], s56 offen offset:0 nt lds
    buffer_load_dwordx4 v8, s[40:43], s56 offen offset:1024 nt lds
    s_waitcnt vmcnt(15)
    s_barrier
    s_add_u32 m0, s53, 0
    s_nop 0
    buffer_load_dwordx4 v1, s[36:39], s57 offen offset:0 lds
    buffer_load_dwordx4 v2, s[36:39], s57 offen offset:1024 lds
    buffer_load_dwordx4 v3, s[36:39], s57 offen offset:2048 lds
    buffer_load_dwordx4 v4, s[36:39], s57 offen offset:3072 lds
    s_add_u32 s57, s57, 131072
    s_waitcnt vmcnt(15)
    s_barrier
    s_add_u32 m0, s53, 16384
    s_nop 0
    buffer_load_dwordx4 v1, s[36:39], s57 offen offset:0 lds
    buffer_load_dwordx4 v2, s[36:39], s57 offen offset:1024 lds
    buffer_load_dwordx4 v3, s[36:39], s57 offen offset:2048 lds
    buffer_load_dwordx4 v4, s[36:39], s57 offen offset:3072 lds
    s_add_u32 s57, s57, 131072
    s_waitcnt vmcnt(14)
    s_barrier
    s_add_u32 m0, s53, 32768
    s_nop 0
    buffer_load_dwordx4 v1, s[36:39], s57 offen offset:0 lds
    buffer_load_dwordx4 v2, s[36:39], s57 offen offset:1024 lds
    buffer_load_dwordx4 v3, s[36:39], s57 offen offset:2048 lds
    buffer_load_dwordx4 v4, s[36:39], s57 offen offset:3072 lds
    s_add_u32 s57, s57, 131072
    s_waitcnt vmcnt(8)
    s_barrier
    s_add_u32 m0, s53, 49152
    s_nop 0
    buffer_load_dwordx4 v1, s[36:39], s57 offen offset:0 lds
    buffer_load_dwordx4 v2, s[36:39], s57 offen offset:1024 lds
    buffer_load_dwordx4 v3, s[36:39], s57 offen offset:2048 lds
    buffer_load_dwordx4 v4, s[36:39], s57 offen offset:3072 lds
    s_add_u32 s57, s57, 131072
    s_cmp_ge_u32 s57, 4718592
    s_cselect_b32 s58, 4718592, 0
    s_sub_u32 s57, s57, s58
    s_waitcnt vmcnt(8)
    s_barrier
    s_add_u32 m0, s53, 0
    s_nop 0
    buffer_load_dwordx4 v1, s[36:39], s57 offen offset:0 lds
    buffer_load_dwordx4 v2, s[36:39], s57 offen offset:1024 lds
    buffer_load_dwordx4 v3, s[36:39], s57 offen offset:2048 lds
    buffer_load_dwordx4 v4, s[36:39], s57 offen offset:3072 lds
    s_add_u32 s57, s57, 131072
    s_waitcnt vmcnt(8)
    s_barrier
    s_add_u32 m0, s53, 16384
    s_nop 0
    buffer_load_dwordx4 v1, s[36:39], s57 offen offset:0 lds
    buffer_load_dwordx4 v2, s[36:39], s57 offen offset:1024 lds
    buffer_load_dwordx4 v3, s[36:39], s57 offen offset:2048 lds
    buffer_load_dwordx4 v4, s[36:39], s57 offen offset:3072 lds
    s_add_u32 s57, s57, 131072
    s_add_u32 m0, s59, 122880
    s_add_u32 s55, s55, 1
    buffer_load_dwordx4 v5, s[32:35], s54 offen offset:0 lds
    buffer_load_dwordx4 v6, s[32:35], s54 offen offset:1024 lds
    s_add_u32 s54, s54, 128
    s_cmp_eq_u32 s55, 9
    s_cselect_b32 s55, 0, s55
    s_cselect_b32 s58, 1152, 0
    s_sub_u32 s54, s54, s58
    s_add_u32 m0, s59, 131072
    s_add_u32 s55, s55, 1
    buffer_load_dwordx4 v5, s[32:35], s54 offen offset:0 lds
    buffer_load_dwordx4 v6, s[32:35], s54 offen offset:1024 lds
    s_add_u32 s54, s54, 128
    s_cmp_eq_u32 s55, 9
    s_cselect_b32 s55, 0, s55
    s_cselect_b32 s58, 1152, 0
    s_sub_u32 s54, s54, s58
    s_add_u32 m0, s59, 73728
    s_add_u32 s56, s59, 8192
    buffer_load_dwordx4 v7, s[40:43], s56 offen offset:0 nt lds
    buffer_load_dwordx4 v8, s[40:43], s56 offen offset:1024 nt lds
    s_add_u32 m0, s59, 81920
    s_add_u32 s56, s59, 131072
    buffer_load_dwordx4 v7, s[40:43], s56 offen offset:0 nt lds
    buffer_load_dwordx4 v8, s[40:43], s56 offen offset:1024 nt lds
    s_add_u32 m0, s59, 90112
    s_add_u32 s56, s59, 139264
    buffer_load_dwordx4 v7, s[40:43], s56 offen offset:0 nt lds
    buffer_load_dwordx4 v8, s[40:43], s56 offen offset:1024 nt lds
    s_waitcnt vmcnt(18)
    s_barrier
    s_add_u32 m0, s53, 32768
    s_nop 0
    buffer_load_dwordx4 v1, s[36:39], s57 offen offset:0 lds
    buffer_load_dwordx4 v2, s[36:39], s57 offen offset:1024 lds
    buffer_load_dwordx4 v3, s[36:39], s57 offen offset:2048 lds
    buffer_load_dwordx4 v4, s[36:39], s57 offen offset:3072 lds
    s_add_u32 s57, s57, 131072
    s_waitcnt vmcnt(18)
    s_barrier
    s_add_u32 m0, s53, 49152
    s_nop 0
    buffer_load_dwordx4 v1, s[36:39], s57 offen offset:0 lds
    buffer_load_dwordx4 v2, s[36:39], s57 offen offset:1024 lds
    buffer_load_dwordx4 v3, s[36:39], s57 offen offset:2048 lds
    buffer_load_dwordx4 v4, s[36:39], s57 offen offset:3072 lds
    s_add_u32 s57, s57, 131072
    s_cmp_ge_u32 s57, 4718592
    s_cselect_b32 s58, 4718592, 0
    s_sub_u32 s57, s57, s58
    s_waitcnt vmcnt(18)
    s_barrier
    s_add_u32 m0, s53, 0
    s_nop 0
    buffer_load_dwordx4 v1, s[36:39], s57 offen offset:0 lds
    buffer_load_dwordx4 v2, s[36:39], s57 offen offset:1024 lds
    buffer_load_dwordx4 v3, s[36:39], s57 offen offset:2048 lds
    buffer_load_dwordx4 v4, s[36:39], s57 offen offset:3072 lds
    s_add_u32 s57, s57, 131072
    s_waitcnt vmcnt(8)
    s_barrier
    s_add_u32 m0, s53, 16384
    s_nop 0
    buffer_load_dwordx4 v1, s[36:39], s57 offen offset:0 lds
    buffer_load_dwordx4 v2, s[36:39], s57 offen offset:1024 lds
    buffer_load_dwordx4 v3, s[36:39], s57 offen offset:2048 lds
    buffer_load_dwordx4 v4, s[36:39], s57 offen offset:3072 lds
    s_add_u32 s57, s57, 131072
    s_waitcnt vmcnt(8)
    s_barrier
    s_add_u32 m0, s53, 32768
    s_nop 0
    buffer_load_dwordx4 v1, s[36:39], s57 offen offset:0 lds
    buffer_load_dwordx4 v2, s[36:39], s57 offen offset:1024 lds
    buffer_load_dwordx4 v3, s[36:39], s57 offen offset:2048 lds
    buffer_load_dwordx4 v4, s[36:39], s57 offen offset:3072 lds
    s_add_u32 s57, s57, 131072
    s_waitcnt vmcnt(8)
    s_barrier
    s_add_u32 m0, s53, 49152
    s_nop 0
    buffer_load_dwordx4 v1, s[36:39], s57 offen offset:0 lds
    buffer_load_dwordx4 v2, s[36:39], s57 offen offset:1024 lds
    buffer_load_dwordx4 v3, s[36:39], s57 offen offset:2048 lds
    buffer_load_dwordx4 v4, s[36:39], s57 offen offset:3072 lds
    s_add_u32 s57, s57, 131072
    s_cmp_ge_u32 s57, 4718592
    s_cselect_b32 s58, 4718592, 0
    s_sub_u32 s57, s57, s58
    s_waitcnt vmcnt(8)
    s_barrier
    s_add_u32 m0, s53, 0
    s_nop 0
    buffer_load_dwordx4 v1, s[36:39], s57 offen offset:0 lds
    buffer_load_dwordx4 v2, s[36:39], s57 offen offset:1024 lds
    buffer_load_dwordx4 v3, s[36:39], s57 offen offset:2048 lds
    buffer_load_dwordx4 v4, s[36:39], s57 offen offset:3072 lds
    s_add_u32 s57, s57, 131072
    s_waitcnt vmcnt(8)
    s_barrier
    s_add_u32 m0, s53, 16384
    s_nop 0
    buffer_load_dwordx4 v1, s[36:39], s57 offen offset:0 lds
    buffer_load_dwordx4 v2, s[36:39], s57 offen offset:1024 lds
    buffer_load_dwordx4 v3, s[36:39], s57 offen offset:2048 lds
    buffer_load_dwordx4 v4, s[36:39], s57 offen offset:3072 lds
    s_add_u32 s57, s57, 131072
    s_add_u32 m0, s59, 139264
    s_add_u32 s55, s55, 1
    buffer_load_dwordx4 v5, s[32:35], s54 offen offset:0 lds
    buffer_load_dwordx4 v6, s[32:35], s54 offen offset:1024 lds
    s_add_u32 s54, s54, 128
    s_cmp_eq_u32 s55, 9
    s_cselect_b32 s55, 0, s55
    s_cselect_b32 s58, 1152, 0
    s_sub_u32 s54, s54, s58
    s_add_u32 m0, s59, 147456
    s_add_u32 s55, s55, 1
    buffer_load_dwordx4 v5, s[32:35], s54 offen offset:0 lds
    buffer_load_dwordx4 v6, s[32:35], s54 offen offset:1024 lds
    s_add_u32 s54, s54, 128
    s_cmp_eq_u32 s55, 9
    s_cselect_b32 s55, 0, s55
    s_cselect_b32 s58, 1152, 0
    s_sub_u32 s54, s54, s58
    s_add_u32 m0, s59, 98304
    s_add_u32 s56, s59, 262144
    buffer_load_dwordx4 v7, s[40:43], s56 offen offset:0 nt lds
    buffer_load_dwordx4 v8, s[40:43], s56 offen offset:1024 nt lds
    s_add_u32 m0, s59, 106496
    s_add_u32 s56, s59, 270336
    buffer_load_dwordx4 v7, s[40:43], s56 offen offset:0 nt lds
    buffer_load_dwordx4 v8, s[40:43], s56 offen offset:1024 nt lds
    s_add_u32 m0, s59, 114688
    s_add_u32 s56, s59, 393216
    buffer_load_dwordx4 v7, s[40:43], s56 offen offset:0 nt lds
    buffer_load_dwordx4 v8, s[40:43], s56 offen offset:1024 nt lds
    s_waitcnt vmcnt(18)
    s_barrier
    s_add_u32 m0, s53, 32768
    s_nop 0
    buffer_load_dwordx4 v1, s[36:39], s57 offen offset:0 lds
    buffer_load_dwordx4 v2, s[36:39], s57 offen offset:1024 lds
    buffer_load_dwordx4 v3, s[36:39], s57 offen offset:2048 lds
    buffer_load_dwordx4 v4, s[36:39], s57 offen offset:3072 lds
    s_add_u32 s57, s57, 131072
    s_waitcnt vmcnt(18)
    s_barrier
    s_add_u32 m0, s53, 49152
    s_nop 0
    buffer_load_dwordx4 v1, s[36:39], s57 offen offset:0 lds
    buffer_load_dwordx4 v2, s[36:39], s57 offen offset:1024 lds
    buffer_load_dwordx4 v3, s[36:39], s57 offen offset:2048 lds
    buffer_load_dwordx4 v4, s[36:39], s57 offen offset:3072 lds
    s_add_u32 s57, s57, 131072
    s_cmp_ge_u32 s57, 4718592
    s_cselect_b32 s58, 4718592, 0
    s_sub_u32 s57, s57, s58
    s_waitcnt vmcnt(18)
    s_barrier
    s_add_u32 m0, s53, 0
    s_nop 0
    buffer_load_dwordx4 v1, s[36:39], s57 offen offset:0 lds
    buffer_load_dwordx4 v2, s[36:39], s57 offen offset:1024 lds
    buffer_load_dwordx4 v3, s[36:39], s57 offen offset:2048 lds
    buffer_load_dwordx4 v4, s[36:39], s57 offen offset:3072 lds
    s_add_u32 s57, s57, 131072
    s_waitcnt vmcnt(8)
    s_barrier
    s_add_u32 m0, s53, 16384
    s_nop 0
    buffer_load_dwordx4 v1, s[36:39], s57 offen offset:0 lds
    buffer_load_dwordx4 v2, s[36:39], s57 offen offset:1024 lds
    buffer_load_dwordx4 v3, s[36:39], s57 offen offset:2048 lds
    buffer_load_dwordx4 v4, s[36:39], s57 offen offset:3072 lds
    s_add_u32 s57, s57, 131072
    s_waitcnt vmcnt(8)
    s_barrier
    s_add_u32 m0, s53, 32768
    s_nop 0
    buffer_load_dwordx4 v1, s[36:39], s57 offen offset:0 lds
    buffer_load_dwordx4 v2, s[36:39], s57 offen offset:1024 lds
    buffer_load_dwordx4 v3, s[36:39], s57 offen offset:2048 lds
    buffer_load_dwordx4 v4, s[36:39], s57 offen offset:3072 lds
    s_add_u32 s57, s57, 131072
    s_waitcnt vmcnt(8)
    s_barrier
    s_add_u32 m0, s53, 49152
    s_nop 0
    buffer_load_dwordx4 v1, s[36:39], s57 offen offset:0 lds
    buffer_load_dwordx4 v2, s[36:39], s57 offen offset:1024 lds
    buffer_load_dwordx4 v3, s[36:39], s57 offen offset:2048 lds
    buffer_load_dwordx4 v4, s[36:39], s57 offen offset:3072 lds
    s_add_u32 s57, s57, 131072
    s_cmp_ge_u32 s57, 4718592
    s_cselect_b32 s58, 4718592, 0
    s_sub_u32 s57, s57, s58
    s_waitcnt vmcnt(8)
    s_barrier
    s_add_u32 m0, s53, 0
    s_nop 0
    buffer_load_dwordx4 v1, s[36:39], s57 offen offset:0 lds
    buffer_load_dwordx4 v2, s[36:39], s57 offen offset:1024 lds
    buffer_load_dwordx4 v3, s[36:39], s57 offen offset:2048 lds
    buffer_load_dwordx4 v4, s[36:39], s57 offen offset:3072 lds
    s_add_u32 s57, s57, 131072
    s_waitcnt vmcnt(8)
    s_barrier
    s_add_u32 m0, s53, 16384
    s_nop 0
    buffer_load_dwordx4 v1, s[36:39], s57 offen offset:0 lds
    buffer_load_dwordx4 v2, s[36:39], s57 offen offset:1024 lds
    buffer_load_dwordx4 v3, s[36:39], s57 offen offset:2048 lds
    buffer_load_dwordx4 v4, s[36:39], s57 offen offset:3072 lds
    s_add_u32 s57, s57, 131072
    s_add_u32 m0, s59, 155648
    s_add_u32 s55, s55, 1
    buffer_load_dwordx4 v5, s[32:35], s54 offen offset:0 lds
    buffer_load_dwordx4 v6, s[32:35], s54 offen offset:1024 lds
    s_add_u32 s54, s54, 128
    s_cmp_eq_u32 s55, 9
    s_cselect_b32 s55, 0, s55
    s_cselect_b32 s58, 1152, 0
    s_sub_u32 s54, s54, s58
    s_add_u32 m0, s59, 122880
    s_add_u32 s56, s59, 401408
    buffer_load_dwordx4 v7, s[40:43], s56 offen offset:0 nt lds
    buffer_load_dwordx4 v8, s[40:43], s56 offen offset:1024 nt lds
    s_add_u32 m0, s59, 131072
    s_add_u32 s56, s59, 0
    buffer_load_dwordx4 v9, s[44:47], s56 offen offset:0 nt lds
    buffer_load_dwordx4 v10, s[44:47], s56 offen offset:1024 nt lds
    s_waitcnt vmcnt(14)
    s_barrier
    s_add_u32 m0, s53, 32768
    s_nop 0
    buffer_load_dwordx4 v1, s[36:39], s57 offen offset:0 lds
    buffer_load_dwordx4 v2, s[36:39], s57 offen offset:1024 lds
    buffer_load_dwordx4 v3, s[36:39], s57 offen offset:2048 lds
    buffer_load_dwordx4 v4, s[36:39], s57 offen offset:3072 lds
    s_add_u32 s57, s57, 131072
    s_waitcnt vmcnt(14)
    s_barrier
    s_add_u32 m0, s53, 49152
    s_nop 0
    buffer_load_dwordx4 v1, s[36:39], s57 offen offset:0 lds
    buffer_load_dwordx4 v2, s[36:39], s57 offen offset:1024 lds
    buffer_load_dwordx4 v3, s[36:39], s57 offen offset:2048 lds
    buffer_load_dwordx4 v4, s[36:39], s57 offen offset:3072 lds
    s_add_u32 s57, s57, 131072
    s_cmp_ge_u32 s57, 4718592
    s_cselect_b32 s58, 4718592, 0
    s_sub_u32 s57, s57, s58
    s_waitcnt vmcnt(14)
    s_barrier
    s_add_u32 m0, s53, 0
    s_nop 0
    buffer_load_dwordx4 v1, s[36:39], s57 offen offset:0 lds
    buffer_load_dwordx4 v2, s[36:39], s57 offen offset:1024 lds
    buffer_load_dwordx4 v3, s[36:39], s57 offen offset:2048 lds
    buffer_load_dwordx4 v4, s[36:39], s57 offen offset:3072 lds
    s_add_u32 s57, s57, 131072
    s_waitcnt vmcnt(8)
    s_barrier
    s_add_u32 m0, s53, 16384
    s_nop 0
    buffer_load_dwordx4 v1, s[36:39], s57 offen offset:0 lds
    buffer_load_dwordx4 v2, s[36:39], s57 offen offset:1024 lds
    buffer_load_dwordx4 v3, s[36:39], s57 offen offset:2048 lds
    buffer_load_dwordx4 v4, s[36:39], s57 offen offset:3072 lds
    s_add_u32 s57, s57, 131072
    s_waitcnt vmcnt(8)
    s_barrier
    s_add_u32 m0, s53, 32768
    s_nop 0
    buffer_load_dwordx4 v1, s[36:39], s57 offen offset:0 lds
    buffer_load_dwordx4 v2, s[36:39], s57 offen offset:1024 lds
    buffer_load_dwordx4 v3, s[36:39], s57 offen offset:2048 lds
    buffer_load_dwordx4 v4, s[36:39], s57 offen offset:3072 lds
    s_add_u32 s57, s57, 131072
    s_waitcnt vmcnt(8)
    s_barrier
    s_add_u32 m0, s53, 49152
    s_nop 0
    buffer_load_dwordx4 v1, s[36:39], s57 offen offset:0 lds
    buffer_load_dwordx4 v2, s[36:39], s57 offen offset:1024 lds
    buffer_load_dwordx4 v3, s[36:39], s57 offen offset:2048 lds
    buffer_load_dwordx4 v4, s[36:39], s57 offen offset:3072 lds
    s_add_u32 s57, s57, 131072
    s_cmp_ge_u32 s57, 4718592
    s_cselect_b32 s58, 4718592, 0
    s_sub_u32 s57, s57, s58
    s_add_u32 m0, s59, 139264
    s_add_u32 s56, s59, 8192
    buffer_load_dwordx4 v9, s[44:47], s56 offen offset:0 nt lds
    buffer_load_dwordx4 v10, s[44:47], s56 offen offset:1024 nt lds
    s_add_u32 m0, s59, 147456
    s_add_u32 s56, s59, 131072
    buffer_load_dwordx4 v9, s[44:47], s56 offen offset:0 nt lds
    buffer_load_dwordx4 v10, s[44:47], s56 offen offset:1024 nt lds
    s_waitcnt vmcnt(12)
    s_barrier
    s_add_u32 m0, s59, 0
    s_add_u32 s56, s59, 262144
    buffer_load_dwordx4 v9, s[44:47], s56 offen offset:0 nt lds
    buffer_load_dwordx4 v10, s[44:47], s56 offen offset:1024 nt lds
    s_waitcnt vmcnt(10)
    s_barrier
    s_add_u32 m0, s59, 8192
    s_add_u32 s56, s59, 270336
    buffer_load_dwordx4 v9, s[44:47], s56 offen offset:0 nt lds
    buffer_load_dwordx4 v10, s[44:47], s56 offen offset:1024 nt lds
    s_waitcnt vmcnt(8)
    s_barrier
    s_waitcnt vmcnt(34)
    s_barrier
    s_add_u32 m0, s59, 16384
    s_add_u32 s56, s59, 393216
    buffer_load_dwordx4 v9, s[44:47], s56 offen offset:0 nt lds
    buffer_load_dwordx4 v10, s[44:47], s56 offen offset:1024 nt lds
    s_add_u32 m0, s59, 24576
    s_add_u32 s56, s59, 401408
    buffer_load_dwordx4 v9, s[44:47], s56 offen offset:0 nt lds
    buffer_load_dwordx4 v10, s[44:47], s56 offen offset:1024 nt lds
    s_add_u32 m0, s59, 155648
    s_add_u32 s56, s59, 139264
    buffer_load_dwordx4 v9, s[44:47], s56 offen offset:0 nt lds
    buffer_load_dwordx4 v10, s[44:47], s56 offen offset:1024 nt lds
L_att:
    s_mul_i32 s47, s51, 36864
    s_lshl_b32 s52, s14, 7
    s_add_u32 s54, s47, s52
    s_mov_b32 s55, s48
    s_add_u32 m0, s53, 32768
    s_nop 0
    buffer_load_dwordx4 v16, s[60:63], s54 offen offset:0 lds
    buffer_load_dwordx4 v17, s[60:63], s54 offen offset:1024 lds
    buffer_load_dwordx4 v18, s[60:63], s54 offen offset:2048 lds
    buffer_load_dwordx4 v19, s[60:63], s54 offen offset:3072 lds
    s_add_u32 s54, s54, 1179648
    s_add_u32 m0, s53, 49152
    s_nop 0
    buffer_load_dwordx4 v16, s[60:63], s54 offen offset:0 lds
    buffer_load_dwordx4 v17, s[60:63], s54 offen offset:1024 lds
    buffer_load_dwordx4 v18, s[60:63], s54 offen offset:2048 lds
    buffer_load_dwordx4 v19, s[60:63], s54 offen offset:3072 lds
    s_add_u32 s54, s54, 1179648
    s_lshl_b32 s45, s51, 1
    s_mul_i32 s52, s50, 589824
    s_add_u32 s36, s28, s52
    s_addc_u32 s37, s29, 0
    s_mov_b32 s38, 589824
    s_mov_b32 s39, 0x20000
    s_mov_b32 s40, s24
    s_mov_b32 s41, s25
    s_mov_b32 s42, 2359296
    s_mov_b32 s43, 0x20000
    s_lshl_b32 s52, s45, 10
    v_lshl_add_u32 v22, v0, 4, s52
    v_lshrrev_b32 v26, 2, v0
    v_and_b32 v27, 3, v0
    v_mul_u32_u24 v23, 2304, v26
    v_lshl_add_u32 v23, v27, 3, v23
    v_lshl_add_u32 v21, v27, 4, v26
    v_lshlrev_b32 v21, 2, v21
    s_and_b32 s52, s45, 3
    s_lshl_b32 s52, s52, 4
    s_lshl_b32 s56, s31, 6
    s_add_u32 s52, s52, s56
    s_mul_i32 s15, s52, 2304
    s_mul_i32 s56, s30, 1152
    s_add_u32 s15, s15, s56
    s_lshr_b32 s56, s45, 2
    s_lshl_b32 s56, s56, 6
    s_add_u32 s15, s15, s56
    s_lshl_b32 s52, s48, 13
    v_add_u32 v22, s52, v22
    v_lshl_add_u32 v20, v0, 4, s59
    s_add_u32 s45, s48, s14
    s_cmp_ge_u32 s45, 8
    s_cselect_b32 s56, -8, 1
    s_add_u32 s45, s45, s56
    s_lshl_b32 s52, s48, 7
    s_lshl_b32 s56, s51, 5
    s_add_u32 s52, s52, s56
    s_mov_b32 s44, s48
    buffer_load_dword v29, v72, s[20:23], 0 offen sc1
    s_waitcnt vmcnt(9)
    s_barrier
    s_add_u32 m0, s53, 65536
    s_nop 0
    buffer_load_dwordx4 v16, s[60:63], s54 offen offset:0 lds
    buffer_load_dwordx4 v17, s[60:63], s54 offen offset:1024 lds
    buffer_load_dwordx4 v18, s[60:63], s54 offen offset:2048 lds
    buffer_load_dwordx4 v19, s[60:63], s54 offen offset:3072 lds
    s_add_u32 s54, s54, 1179648
    s_add_u32 m0, s53, 81920
    s_add_u32 s55, s55, 1
    buffer_load_dwordx4 v16, s[60:63], s54 offen offset:0 lds
    buffer_load_dwordx4 v17, s[60:63], s54 offen offset:1024 lds
    buffer_load_dwordx4 v18, s[60:63], s54 offen offset:2048 lds
    buffer_load_dwordx4 v19, s[60:63], s54 offen offset:3072 lds
    s_and_b32 s55, s55, 7
    s_add_u32 s58, s55, s14
    s_cmp_ge_u32 s58, 8
    s_cselect_b32 s56, -8, 1
    s_add_u32 s58, s58, s56
    s_lshl_b32 s58, s58, 7
    s_add_u32 s54, s58, s47
    s_waitcnt vmcnt(13)
    s_barrier
    s_add_u32 m0, s53, 98304
    s_nop 0
    buffer_load_dwordx4 v16, s[60:63], s54 offen offset:0 lds
    buffer_load_dwordx4 v17, s[60:63], s54 offen offset:1024 lds
    buffer_load_dwordx4 v18, s[60:63], s54 offen offset:2048 lds
    buffer_load_dwordx4 v19, s[60:63], s54 offen offset:3072 lds
    s_add_u32 s54, s54, 1179648
    s_add_u32 m0, s53, 114688
    s_nop 0
    buffer_load_dwordx4 v16, s[60:63], s54 offen offset:0 lds
    buffer_load_dwordx4 v17, s[60:63], s54 offen offset:1024 lds
    buffer_load_dwordx4 v18, s[60:63], s54 offen offset:2048 lds
    buffer_load_dwordx4 v19, s[60:63], s54 offen offset:3072 lds
    s_add_u32 s54, s54, 1179648
    s_waitcnt vmcnt(12)
    s_barrier
    s_add_u32 m0, s53, 131072
    s_nop 0
    buffer_load_dwordx4 v16, s[60:63], s54 offen offset:0 lds
    buffer_load_dwordx4 v17, s[60:63], s54 offen offset:1024 lds
    buffer_load_dwordx4 v18, s[60:63], s54 offen offset:2048 lds
    buffer_load_dwordx4 v19, s[60:63], s54 offen offset:3072 lds
    s_add_u32 s54, s54, 1179648
    s_add_u32 m0, s53, 147456
    s_add_u32 s55, s55, 1
    buffer_load_dwordx4 v16, s[60:63], s54 offen offset:0 lds
    buffer_load_dwordx4 v17, s[60:63], s54 offen offset:1024 lds
    buffer_load_dwordx4 v18, s[60:63], s54 offen offset:2048 lds
    buffer_load_dwordx4 v19, s[60:63], s54 offen offset:3072 lds
    s_and_b32 s55, s55, 7
    s_add_u32 s58, s55, s14
    s_cmp_ge_u32 s58, 8
    s_cselect_b32 s56, -8, 1
    s_add_u32 s58, s58, s56
    s_lshl_b32 s58, s58, 7
    s_add_u32 s54, s58, s47
    s_waitcnt vmcnt(12)
    s_barrier
    s_waitcnt vmcnt(24)
    s_mov_b32 s46, 0x8000
L_dbg:
    v_cmp_ne_u32 vcc, 1, v29
    s_sub_u32 s46, s46, 1
    s_cbranch_scc1 L_dbg_ok
    s_nop 3
    s_cbranch_vccz L_dbg_ok
    s_sleep 8
    buffer_load_dword v29, v72, s[20:23], 0 offen sc1
    s_waitcnt vmcnt(0)
    s_branch L_dbg
L_dbg_ok:
    s_add_u32 m0, s53, 0
    s_nop 0
    buffer_load_dwordx4 v16, s[60:63], s54 offen offset:0 lds
    buffer_load_dwordx4 v17, s[60:63], s54 offen offset:1024 lds
    buffer_load_dwordx4 v18, s[60:63], s54 offen offset:2048 lds
    buffer_load_dwordx4 v19, s[60:63], s54 offen offset:3072 lds
    s_add_u32 s54, s54, 1179648
    s_add_u32 m0, s53, 16384
    s_nop 0
    buffer_load_dwordx4 v16, s[60:63], s54 offen offset:0 lds
    buffer_load_dwordx4 v17, s[60:63], s54 offen offset:1024 lds
    buffer_load_dwordx4 v18, s[60:63], s54 offen offset:2048 lds
    buffer_load_dwordx4 v19, s[60:63], s54 offen offset:3072 lds
    s_add_u32 s54, s54, 1179648
    s_waitcnt vmcnt(12)
    s_barrier
    s_add_u32 m0, s53, 32768
    s_nop 0
    buffer_load_dwordx4 v16, s[60:63], s54 offen offset:0 lds
    buffer_load_dwordx4 v17, s[60:63], s54 offen offset:1024 lds
    buffer_load_dwordx4 v18, s[60:63], s54 offen offset:2048 lds
    buffer_load_dwordx4 v19, s[60:63], s54 offen offset:3072 lds
    s_add_u32 s54, s54, 1179648
    s_add_u32 m0, s53, 49152
    s_add_u32 s55, s55, 1
    buffer_load_dwordx4 v16, s[60:63], s54 offen offset:0 lds
    buffer_load_dwordx4 v17, s[60:63], s54 offen offset:1024 lds
    buffer_load_dwordx4 v18, s[60:63], s54 offen offset:2048 lds
    buffer_load_dwordx4 v19, s[60:63], s54 offen offset:3072 lds
    s_and_b32 s55, s55, 7
    s_add_u32 s58, s55, s14
    s_cmp_ge_u32 s58, 8
    s_cselect_b32 s56, -8, 1
    s_add_u32 s58, s58, s56
    s_lshl_b32 s58, s58, 7
    s_add_u32 s54, s58, s47
    s_waitcnt vmcnt(12)
    s_barrier
    s_add_u32 m0, s53, 65536
    s_nop 0
    buffer_load_dwordx4 v16, s[60:63], s54 offen offset:0 lds
    buffer_load_dwordx4 v17, s[60:63], s54 offen offset:1024 lds
    buffer_load_dwordx4 v18, s[60:63], s54 offen offset:2048 lds
    buffer_load_dwordx4 v19, s[60:63], s54 offen offset:3072 lds
    s_add_u32 s54, s54, 1179648
    s_add_u32 m0, s53, 81920
    s_nop 0
    buffer_load_dwordx4 v16, s[60:63], s54 offen offset:0 lds
    buffer_load_dwordx4 v17, s[60:63], s54 offen offset:1024 lds
    buffer_load_dwordx4 v18, s[60:63], s54 offen offset:2048 lds
    buffer_load_dwordx4 v19, s[60:63], s54 offen offset:3072 lds
    s_add_u32 s54, s54, 1179648
    s_waitcnt vmcnt(12)
    s_barrier
    s_add_u32 m0, s53, 98304
    s_nop 0
    buffer_load_dwordx4 v16, s[60:63], s54 offen offset:0 lds
    buffer_load_dwordx4 v17, s[60:63], s54 offen offset:1024 lds
    buffer_load_dwordx4 v18, s[60:63], s54 offen offset:2048 lds
    buffer_load_dwordx4 v19, s[60:63], s54 offen offset:3072 lds
    s_add_u32 s54, s54, 1179648
    s_add_u32 m0, s53, 114688
    s_add_u32 s55, s55, 1
    buffer_load_dwordx4 v16, s[60:63], s54 offen offset:0 lds
    buffer_load_dwordx4 v17, s[60:63], s54 offen offset:1024 lds
    buffer_load_dwordx4 v18, s[60:63], s54 offen offset:2048 lds
    buffer_load_dwordx4 v19, s[60:63], s54 offen offset:3072 lds
    s_and_b32 s55, s55, 7
    s_add_u32 s58, s55, s14
    s_cmp_ge_u32 s58, 8
    s_cselect_b32 s56, -8, 1
    s_add_u32 s58, s58, s56
    s_lshl_b32 s58, s58, 7
    s_add_u32 s54, s58, s47
    s_waitcnt vmcnt(12)
    s_barrier
    s_add_u32 m0, s53, 131072
    s_nop 0
    buffer_load_dwordx4 v16, s[60:63], s54 offen offset:0 lds
    buffer_load_dwordx4 v17, s[60:63], s54 offen offset:1024 lds
    buffer_load_dwordx4 v18, s[60:63], s54 offen offset:2048 lds
    buffer_load_dwordx4 v19, s[60:63], s54 offen offset:3072 lds
    s_add_u32 s54, s54, 1179648
    s_add_u32 m0, s53, 147456
    s_nop 0
    buffer_load_dwordx4 v16, s[60:63], s54 offen offset:0 lds
    buffer_load_dwordx4 v17, s[60:63], s54 offen offset:1024 lds
    buffer_load_dwordx4 v18, s[60:63], s54 offen offset:2048 lds
    buffer_load_dwordx4 v19, s[60:63], s54 offen offset:3072 lds
    s_add_u32 s54, s54, 1179648
    s_waitcnt vmcnt(12)
    s_barrier
    s_add_u32 m0, s53, 0
    s_nop 0
    buffer_load_dwordx4 v16, s[60:63], s54 offen offset:0 lds
    buffer_load_dwordx4 v17, s[60:63], s54 offen offset:1024 lds
    buffer_load_dwordx4 v18, s[60:63], s54 offen offset:2048 lds
    buffer_load_dwordx4 v19, s[60:63], s54 offen offset:3072 lds
    s_add_u32 s54, s54, 1179648
    s_waitcnt vmcnt(8)
    s_barrier
    s_add_u32 m0, s53, 16384
    s_add_u32 s55, s55, 1
    buffer_load_dwordx4 v16, s[60:63], s54 offen offset:0 lds
    buffer_load_dwordx4 v17, s[60:63], s54 offen offset:1024 lds
    buffer_load_dwordx4 v18, s[60:63], s54 offen offset:2048 lds
    buffer_load_dwordx4 v19, s[60:63], s54 offen offset:3072 lds
    s_and_b32 s55, s55, 7
    s_add_u32 s58, s55, s14
    s_cmp_ge_u32 s58, 8
    s_cselect_b32 s56, -8, 1
    s_add_u32 s58, s58, s56
    s_lshl_b32 s58, s58, 7
    s_add_u32 s54, s58, s47
    s_add_u32 m0, s53, 32768
    s_nop 0
    buffer_load_dwordx4 v16, s[60:63], s54 offen offset:0 lds
    buffer_load_dwordx4 v17, s[60:63], s54 offen offset:1024 lds
    buffer_load_dwordx4 v18, s[60:63], s54 offen offset:2048 lds
    buffer_load_dwordx4 v19, s[60:63], s54 offen offset:3072 lds
    s_add_u32 s54, s54, 1179648
    s_waitcnt vmcnt(8)
    s_barrier
    s_add_u32 m0, s53, 49152
    s_nop 0
    buffer_load_dwordx4 v16, s[60:63], s54 offen offset:0 lds
    buffer_load_dwordx4 v17, s[60:63], s54 offen offset:1024 lds
    buffer_load_dwordx4 v18, s[60:63], s54 offen offset:2048 lds
    buffer_load_dwordx4 v19, s[60:63], s54 offen offset:3072 lds
    s_add_u32 s54, s54, 1179648
    s_add_u32 m0, s53, 65536
    s_nop 0
    buffer_load_dwordx4 v16, s[60:63], s54 offen offset:0 lds
    buffer_load_dwordx4 v17, s[60:63], s54 offen offset:1024 lds
    buffer_load_dwordx4 v18, s[60:63], s54 offen offset:2048 lds
    buffer_load_dwordx4 v19, s[60:63], s54 offen offset:3072 lds
    s_add_u32 s54, s54, 1179648
    s_waitcnt vmcnt(8)
    s_barrier
    s_add_u32 m0, s53, 81920
    s_add_u32 s55, s55, 1
    buffer_load_dwordx4 v16, s[60:63], s54 offen offset:0 lds
    buffer_load_dwordx4 v17, s[60:63], s54 offen offset:1024 lds
    buffer_load_dwordx4 v18, s[60:63], s54 offen offset:2048 lds
    buffer_load_dwordx4 v19, s[60:63], s54 offen offset:3072 lds
    s_and_b32 s55, s55, 7
    s_add_u32 s58, s55, s14
    s_cmp_ge_u32 s58, 8
    s_cselect_b32 s56, -8, 1
    s_add_u32 s58, s58, s56
    s_lshl_b32 s58, s58, 7
    s_add_u32 s54, s58, s47
    s_add_u32 m0, s53, 98304
    s_nop 0
    buffer_load_dwordx4 v16, s[60:63], s54 offen offset:0 lds
    buffer_load_dwordx4 v17, s[60:63], s54 offen offset:1024 lds
    buffer_load_dwordx4 v18, s[60:63], s54 offen offset:2048 lds
    buffer_load_dwordx4 v19, s[60:63], s54 offen offset:3072 lds
    s_add_u32 s54, s54, 1179648
    s_waitcnt vmcnt(8)
    s_barrier
    s_add_u32 m0, s53, 114688
    s_nop 0
    buffer_load_dwordx4 v16, s[60:63], s54 offen offset:0 lds
    buffer_load_dwordx4 v17, s[60:63], s54 offen offset:1024 lds
    buffer_load_dwordx4 v18, s[60:63], s54 offen offset:2048 lds
    buffer_load_dwordx4 v19, s[60:63], s54 offen offset:3072 lds
    s_add_u32 s54, s54, 1179648
    s_waitcnt vmcnt(4)
    s_barrier
    s_add_u32 m0, s53, 131072
    s_nop 0
    buffer_load_dwordx4 v16, s[60:63], s54 offen offset:0 lds
    buffer_load_dwordx4 v17, s[60:63], s54 offen offset:1024 lds
    buffer_load_dwordx4 v18, s[60:63], s54 offen offset:2048 lds
    buffer_load_dwordx4 v19, s[60:63], s54 offen offset:3072 lds
    s_add_u32 s54, s54, 1179648
    s_add_u32 m0, s53, 147456
    s_add_u32 s55, s55, 1
    buffer_load_dwordx4 v16, s[60:63], s54 offen offset:0 lds
    buffer_load_dwordx4 v17, s[60:63], s54 offen offset:1024 lds
    buffer_load_dwordx4 v18, s[60:63], s54 offen offset:2048 lds
    buffer_load_dwordx4 v19, s[60:63], s54 offen offset:3072 lds
    s_and_b32 s55, s55, 7
    s_add_u32 s58, s55, s14
    s_cmp_ge_u32 s58, 8
    s_cselect_b32 s56, -8, 1
    s_add_u32 s58, s58, s56
    s_lshl_b32 s58, s58, 7
    s_add_u32 s54, s58, s47
    s_waitcnt vmcnt(4)
    s_barrier
    s_add_u32 m0, s53, 0
    s_nop 0
    buffer_load_dwordx4 v16, s[60:63], s54 offen offset:0 lds
    buffer_load_dwordx4 v17, s[60:63], s54 offen offset:1024 lds
    buffer_load_dwordx4 v18, s[60:63], s54 offen offset:2048 lds
    buffer_load_dwordx4 v19, s[60:63], s54 offen offset:3072 lds
    s_add_u32 s54, s54, 1179648
    s_add_u32 m0, s53, 16384
    s_nop 0
    buffer_load_dwordx4 v16, s[60:63], s54 offen offset:0 lds
    buffer_load_dwordx4 v17, s[60:63], s54 offen offset:1024 lds
    buffer_load_dwordx4 v18, s[60:63], s54 offen offset:2048 lds
    buffer_load_dwordx4 v19, s[60:63], s54 offen offset:3072 lds
    s_add_u32 s54, s54, 1179648
    s_waitcnt vmcnt(4)
    s_barrier
    s_add_u32 m0, s53, 32768
    s_nop 0
    buffer_load_dwordx4 v16, s[60:63], s54 offen offset:0 lds
    buffer_load_dwordx4 v17, s[60:63], s54 offen offset:1024 lds
    buffer_load_dwordx4 v18, s[60:63], s54 offen offset:2048 lds
    buffer_load_dwordx4 v19, s[60:63], s54 offen offset:3072 lds
    s_add_u32 s54, s54, 1179648
    s_add_u32 m0, s53, 49152
    s_add_u32 s55, s55, 1
    buffer_load_dwordx4 v16, s[60:63], s54 offen offset:0 lds
    buffer_load_dwordx4 v17, s[60:63], s54 offen offset:1024 lds
    buffer_load_dwordx4 v18, s[60:63], s54 offen offset:2048 lds
    buffer_load_dwordx4 v19, s[60:63], s54 offen offset:3072 lds
    s_and_b32 s55, s55, 7
    s_add_u32 s58, s55, s14
    s_cmp_ge_u32 s58, 8
    s_cselect_b32 s56, -8, 1
    s_add_u32 s58, s58, s56
    s_lshl_b32 s58, s58, 7
    s_add_u32 s54, s58, s47
    s_waitcnt vmcnt(4)
    s_barrier
    s_add_u32 m0, s53, 65536
    s_nop 0
    buffer_load_dwordx4 v16, s[60:63], s54 offen offset:0 lds
    buffer_load_dwordx4 v17, s[60:63], s54 offen offset:1024 lds
    buffer_load_dwordx4 v18, s[60:63], s54 offen offset:2048 lds
    buffer_load_dwordx4 v19, s[60:63], s54 offen offset:3072 lds
    s_add_u32 s54, s54, 1179648
    s_add_u32 m0, s53, 81920
    s_nop 0
    buffer_load_dwordx4 v16, s[60:63], s54 offen offset:0 lds
    buffer_load_dwordx4 v17, s[60:63], s54 offen offset:1024 lds
    buffer_load_dwordx4 v18, s[60:63], s54 offen offset:2048 lds
    buffer_load_dwordx4 v19, s[60:63], s54 offen offset:3072 lds
    s_add_u32 s54, s54, 1179648
    s_load_dwordx8 s[72:79], s[16:17], s52 glc
    s_waitcnt vmcnt(4)
    s_barrier
    s_add_u32 m0, s53, 98304
    s_nop 0
    buffer_load_dwordx4 v16, s[60:63], s54 offen offset:0 lds
    buffer_load_dwordx4 v17, s[60:63], s54 offen offset:1024 lds
    buffer_load_dwordx4 v18, s[60:63], s54 offen offset:2048 lds
    buffer_load_dwordx4 v19, s[60:63], s54 offen offset:3072 lds
    s_add_u32 s54, s54, 1179648
    s_add_u32 m0, s53, 114688
    s_add_u32 s55, s55, 1
    buffer_load_dwordx4 v16, s[60:63], s54 offen offset:0 lds
    buffer_load_dwordx4 v17, s[60:63], s54 offen offset:1024 lds
    buffer_load_dwordx4 v18, s[60:63], s54 offen offset:2048 lds
    buffer_load_dwordx4 v19, s[60:63], s54 offen offset:3072 lds
    s_and_b32 s55, s55, 7
    s_add_u32 s58, s55, s14
    s_cmp_ge_u32 s58, 8
    s_cselect_b32 s56, -8, 1
    s_add_u32 s58, s58, s56
    s_lshl_b32 s58, s58, 7
    s_add_u32 s54, s58, s47
    s_mov_b32 s46, 0x10000
L_pa:
    s_waitcnt lgkmcnt(0)
    s_lshl1_add_u32 s79, s79, s78
    s_lshl1_add_u32 s79, s79, s77
    s_lshl1_add_u32 s79, s79, s76
    s_lshl1_add_u32 s79, s79, s75
    s_lshl1_add_u32 s79, s79, s74
    s_lshl1_add_u32 s79, s79, s73
    s_lshl1_add_u32 s79, s79, s72
    s_mul_i32 s79, s79, 0x101
    s_lshr_b32 s79, s79, s48
    s_and_b32 s79, s79, 240
    s_cmp_eq_u32 s79, 240
    s_cbranch_scc1 L_pa_ok
    s_sub_u32 s46, s46, 1
    s_cbranch_scc1 L_pa_ok
    s_sleep 1
    s_load_dwordx8 s[72:79], s[16:17], s52 glc
    s_branch L_pa
L_pa_ok:
    s_sub_u32 s44, s44, 1
    s_and_b32 s44, s44, 7
    s_mul_i32 s57, s44, 73728
    buffer_load_dwordx4 v[80:83], v22, s[36:39], s57 offen offset:0 sc1
    buffer_load_dwordx4 v[84:87], v22, s[36:39], s57 offen offset:1024 sc1
    s_sub_u32 s44, s44, 1
    s_and_b32 s44, s44, 7
    s_mul_i32 s57, s44, 73728
    buffer_load_dwordx4 v[88:91], v22, s[36:39], s57 offen offset:0 sc1
    buffer_load_dwordx4 v[92:95], v22, s[36:39], s57 offen offset:1024 sc1
    s_waitcnt vmcnt(8)
    s_barrier
    s_sub_u32 s44, s44, 1
    s_and_b32 s44, s44, 7
    s_mul_i32 s57, s44, 73728
    buffer_load_dwordx4 v[96:99], v22, s[36:39], s57 offen offset:0 sc1
    buffer_load_dwordx4 v[100:103], v22, s[36:39], s57 offen offset:1024 sc1
    s_sub_u32 s44, s44, 1
    s_and_b32 s44, s44, 7
    s_mul_i32 s57, s44, 73728
    buffer_load_dwordx4 v[104:107], v22, s[36:39], s57 offen offset:0 sc1
    buffer_load_dwordx4 v[108:111], v22, s[36:39], s57 offen offset:1024 sc1
    s_load_dwordx8 s[72:79], s[16:17], s52 glc
    s_waitcnt vmcnt(8)
    s_barrier
    s_mov_b32 s46, 0x10000
L_pc4:
    s_waitcnt lgkmcnt(0)
    s_lshl1_add_u32 s79, s79, s78
    s_lshl1_add_u32 s79, s79, s77
    s_lshl1_add_u32 s79, s79, s76
    s_lshl1_add_u32 s79, s79, s75
    s_lshl1_add_u32 s79, s79, s74
    s_lshl1_add_u32 s79, s79, s73
    s_lshl1_add_u32 s79, s79, s72
    s_mul_i32 s79, s79, 0x101
    s_lshr_b32 s79, s79, s48
    s_and_b32 s79, s79, 8
    s_cmp_eq_u32 s79, 8
    s_cbranch_scc1 L_pc4_ok
    s_sub_u32 s46, s46, 1
    s_cbranch_scc1 L_pc4_ok
    s_sleep 1
    s_load_dwordx8 s[72:79], s[16:17], s52 glc
    s_branch L_pc4
L_pc4_ok:
    s_sub_u32 s44, s44, 1
    s_and_b32 s44, s44, 7
    s_mul_i32 s57, s44, 73728
    buffer_load_dwordx4 v[112:115], v22, s[36:39], s57 offen offset:0 sc1
    buffer_load_dwordx4 v[116:119], v22, s[36:39], s57 offen offset:1024 sc1
    s_load_dwordx8 s[72:79], s[16:17], s52 glc
    s_waitcnt vmcnt(9)
    v_lshlrev_b32 v64, 16, v80
    v_and_b32 v65, 0xffff0000, v80
    v_lshlrev_b32 v66, 16, v81
    v_and_b32 v67, 0xffff0000, v81
    v_lshlrev_b32 v68, 16, v82
    v_and_b32 v69, 0xffff0000, v82
    v_lshlrev_b32 v70, 16, v83
    v_and_b32 v71, 0xffff0000, v83
    s_waitcnt vmcnt(8)
    v_lshlrev_b32 v152, 16, v84
    v_and_b32 v153, 0xffff0000, v84
    v_lshlrev_b32 v154, 16, v85
    v_and_b32 v155, 0xffff0000, v85
    v_lshlrev_b32 v156, 16, v86
    v_and_b32 v157, 0xffff0000, v86
    v_lshlrev_b32 v158, 16, v87
    v_and_b32 v159, 0xffff0000, v87
    s_waitcnt vmcnt(7)
    v_lshlrev_b32 v60, 16, v88
    v_and_b32 v61, 0xffff0000, v88
    v_pk_add_f32 v[64:65], v[64:65], v[60:61]
    v_lshlrev_b32 v60, 16, v89
    v_and_b32 v61, 0xffff0000, v89
    v_pk_add_f32 v[66:67], v[66:67], v[60:61]
    v_lshlrev_b32 v60, 16, v90
    v_and_b32 v61, 0xffff0000, v90
    v_pk_add_f32 v[68:69], v[68:69], v[60:61]
    v_lshlrev_b32 v60, 16, v91
    v_and_b32 v61, 0xffff0000, v91
    v_pk_add_f32 v[70:71], v[70:71], v[60:61]
    s_waitcnt vmcnt(6)
    v_lshlrev_b32 v60, 16, v92
    v_and_b32 v61, 0xffff0000, v92
    v_pk_add_f32 v[152:153], v[152:153], v[60:61]
    v_lshlrev_b32 v60, 16, v93
    v_and_b32 v61, 0xffff0000, v93
    v_pk_add_f32 v[154:155], v[154:155], v[60:61]
    v_lshlrev_b32 v60, 16, v94
    v_and_b32 v61, 0xffff0000, v94
    v_pk_add_f32 v[156:157], v[156:157], v[60:61]
    v_lshlrev_b32 v60, 16, v95
    v_and_b32 v61, 0xffff0000, v95
    v_pk_add_f32 v[158:159], v[158:159], v[60:61]
    s_waitcnt vmcnt(5)
    v_lshlrev_b32 v60, 16, v96
    v_and_b32 v61, 0xffff0000, v96
    v_pk_add_f32 v[64:65], v[64:65], v[60:61]
    v_lshlrev_b32 v60, 16, v97
    v_and_b32 v61, 0xffff0000, v97
    v_pk_add_f32 v[66:67], v[66:67], v[60:61]
    v_lshlrev_b32 v60, 16, v98
    v_and_b32 v61, 0xffff0000, v98
    v_pk_add_f32 v[68:69], v[68:69], v[60:61]
    v_lshlrev_b32 v60, 16, v99
    v_and_b32 v61, 0xffff0000, v99
    v_pk_add_f32 v[70:71], v[70:71], v[60:61]
    s_waitcnt vmcnt(4)
    v_lshlrev_b32 v60, 16, v100
    v_and_b32 v61, 0xffff0000, v100
    v_pk_add_f32 v[152:153], v[152:153], v[60:61]
    v_lshlrev_b32 v60, 16, v101
    v_and_b32 v61, 0xffff0000, v101
    v_pk_add_f32 v[154:155], v[154:155], v[60:61]
    v_lshlrev_b32 v60, 16, v102
    v_and_b32 v61, 0xffff0000, v102
    v_pk_add_f32 v[156:157], v[156:157], v[60:61]
    v_lshlrev_b32 v60, 16, v103
    v_and_b32 v61, 0xffff0000, v103
    v_pk_add_f32 v[158:159], v[158:159], v[60:61]
    s_waitcnt vmcnt(3)
    v_lshlrev_b32 v60, 16, v104
    v_and_b32 v61, 0xffff0000, v104
    v_pk_add_f32 v[64:65], v[64:65], v[60:61]
    v_lshlrev_b32 v60, 16, v105
    v_and_b32 v61, 0xffff0000, v105
    v_pk_add_f32 v[66:67], v[66:67], v[60:61]
    v_lshlrev_b32 v60, 16, v106
    v_and_b32 v61, 0xffff0000, v106
    v_pk_add_f32 v[68:69], v[68:69], v[60:61]
    v_lshlrev_b32 v60, 16, v107
    v_and_b32 v61, 0xffff0000, v107
    v_pk_add_f32 v[70:71], v[70:71], v[60:61]
    s_waitcnt vmcnt(2)
    v_lshlrev_b32 v60, 16, v108
    v_and_b32 v61, 0xffff0000, v108
    v_pk_add_f32 v[152:153], v[152:153], v[60:61]
    v_lshlrev_b32 v60, 16, v109
    v_and_b32 v61, 0xffff0000, v109
    v_pk_add_f32 v[154:155], v[154:155], v[60:61]
    v_lshlrev_b32 v60, 16, v110
    v_and_b32 v61, 0xffff0000, v110
    v_pk_add_f32 v[156:157], v[156:157], v[60:61]
    v_lshlrev_b32 v60, 16, v111
    v_and_b32 v61, 0xffff0000, v111
    v_pk_add_f32 v[158:159], v[158:159], v[60:61]
    s_waitcnt vmcnt(1)
    v_lshlrev_b32 v60, 16, v112
    v_and_b32 v61, 0xffff0000, v112
    v_pk_add_f32 v[64:65], v[64:65], v[60:61]
    v_lshlrev_b32 v60, 16, v113
    v_and_b32 v61, 0xffff0000, v113
    v_pk_add_f32 v[66:67], v[66:67], v[60:61]
    v_lshlrev_b32 v60, 16, v114
    v_and_b32 v61, 0xffff0000, v114
    v_pk_add_f32 v[68:69], v[68:69], v[60:61]
    v_lshlrev_b32 v60, 16, v115
    v_and_b32 v61, 0xffff0000, v115
    v_pk_add_f32 v[70:71], v[70:71], v[60:61]
    s_waitcnt vmcnt(0)
    v_lshlrev_b32 v60, 16, v116
    v_and_b32 v61, 0xffff0000, v116
    v_pk_add_f32 v[152:153], v[152:153], v[60:61]
    v_lshlrev_b32 v60, 16, v117
    v_and_b32 v61, 0xffff0000, v117
    v_pk_add_f32 v[154:155], v[154:155], v[60:61]
    v_lshlrev_b32 v60, 16, v118
    v_and_b32 v61, 0xffff0000, v118
    v_pk_add_f32 v[156:157], v[156:157], v[60:61]
    v_lshlrev_b32 v60, 16, v119
    v_and_b32 v61, 0xffff0000, v119
    v_pk_add_f32 v[158:159], v[158:159], v[60:61]
    s_mov_b32 s46, 0x10000
L_p5:
    s_waitcnt lgkmcnt(0)
    s_lshl1_add_u32 s79, s79, s78
    s_lshl1_add_u32 s79, s79, s77
    s_lshl1_add_u32 s79, s79, s76
    s_lshl1_add_u32 s79, s79, s75
    s_lshl1_add_u32 s79, s79, s74
    s_lshl1_add_u32 s79, s79, s73
    s_lshl1_add_u32 s79, s79, s72
    s_mul_i32 s79, s79, 0x101
    s_lshr_b32 s79, s79, s48
    s_and_b32 s79, s79, 4
    s_cmp_eq_u32 s79, 4
    s_cbranch_scc1 L_p5_ok
    s_sub_u32 s46, s46, 1
    s_cbranch_scc1 L_p5_ok
    s_sleep 1
    s_load_dwordx8 s[72:79], s[16:17], s52 glc
    s_branch L_p5
L_p5_ok:
    s_sub_u32 s44, s44, 1
    s_and_b32 s44, s44, 7
    s_mul_i32 s57, s44, 73728
    buffer_load_dwordx4 v[120:123], v22, s[36:39], s57 offen offset:0 sc1
    buffer_load_dwordx4 v[124:127], v22, s[36:39], s57 offen offset:1024 sc1
    s_load_dwordx8 s[72:79], s[16:17], s52 glc
    s_barrier
    ds_read_b128 v[136:139], v20 offset:0
    ds_read_b128 v[140:143], v20 offset:1024
    s_mov_b32 s46, 0x10000
L_p6:
    s_waitcnt lgkmcnt(0)
    s_lshl1_add_u32 s79, s79, s78
    s_lshl1_add_u32 s79, s79, s77
    s_lshl1_add_u32 s79, s79, s76
    s_lshl1_add_u32 s79, s79, s75
    s_lshl1_add_u32 s79, s79, s74
    s_lshl1_add_u32 s79, s79, s73
    s_lshl1_add_u32 s79, s79, s72
    s_mul_i32 s79, s79, 0x101
    s_lshr_b32 s79, s79, s48
    s_and_b32 s79, s79, 2
    s_cmp_eq_u32 s79, 2
    s_cbranch_scc1 L_p6_ok
    s_sub_u32 s46, s46, 1
    s_cbranch_scc1 L_p6_ok
    s_sleep 1
    s_load_dwordx8 s[72:79], s[16:17], s52 glc
    s_branch L_p6
L_p6_ok:
    s_sub_u32 s44, s44, 1
    s_and_b32 s44, s44, 7
    s_mul_i32 s57, s44, 73728
    buffer_load_dwordx4 v[128:131], v22, s[36:39], s57 offen offset:0 sc1
    buffer_load_dwordx4 v[132:135], v22, s[36:39], s57 offen offset:1024 sc1
    v_lshlrev_b32 v60, 16, v136
    v_and_b32 v61, 0xffff0000, v136
    v_pk_add_f32 v[64:65], v[64:65], v[60:61]
    v_lshlrev_b32 v60, 16, v137
    v_and_b32 v61, 0xffff0000, v137
    v_pk_add_f32 v[66:67], v[66:67], v[60:61]
    v_lshlrev_b32 v60, 16, v138
    v_and_b32 v61, 0xffff0000, v138
    v_pk_add_f32 v[68:69], v[68:69], v[60:61]
    v_lshlrev_b32 v60, 16, v139
    v_and_b32 v61, 0xffff0000, v139
    v_pk_add_f32 v[70:71], v[70:71], v[60:61]
    v_lshlrev_b32 v60, 16, v140
    v_and_b32 v61, 0xffff0000, v140
    v_pk_add_f32 v[152:153], v[152:153], v[60:61]
    v_lshlrev_b32 v60, 16, v141
    v_and_b32 v61, 0xffff0000, v141
    v_pk_add_f32 v[154:155], v[154:155], v[60:61]
    v_lshlrev_b32 v60, 16, v142
    v_and_b32 v61, 0xffff0000, v142
    v_pk_add_f32 v[156:157], v[156:157], v[60:61]
    v_lshlrev_b32 v60, 16, v143
    v_and_b32 v61, 0xffff0000, v143
    v_pk_add_f32 v[158:159], v[158:159], v[60:61]
    s_waitcnt vmcnt(3)
    v_lshlrev_b32 v60, 16, v120
    v_and_b32 v61, 0xffff0000, v120
    v_pk_add_f32 v[64:65], v[64:65], v[60:61]
    v_lshlrev_b32 v60, 16, v121
    v_and_b32 v61, 0xffff0000, v121
    v_pk_add_f32 v[66:67], v[66:67], v[60:61]
    v_lshlrev_b32 v60, 16, v122
    v_and_b32 v61, 0xffff0000, v122
    v_pk_add_f32 v[68:69], v[68:69], v[60:61]
    v_lshlrev_b32 v60, 16, v123
    v_and_b32 v61, 0xffff0000, v123
    v_pk_add_f32 v[70:71], v[70:71], v[60:61]
    s_waitcnt vmcnt(2)
    v_lshlrev_b32 v60, 16, v124
    v_and_b32 v61, 0xffff0000, v124
    v_pk_add_f32 v[152:153], v[152:153], v[60:61]
    v_lshlrev_b32 v60, 16, v125
    v_and_b32 v61, 0xffff0000, v125
    v_pk_add_f32 v[154:155], v[154:155], v[60:61]
    v_lshlrev_b32 v60, 16, v126
    v_and_b32 v61, 0xffff0000, v126
    v_pk_add_f32 v[156:157], v[156:157], v[60:61]
    v_lshlrev_b32 v60, 16, v127
    v_and_b32 v61, 0xffff0000, v127
    v_pk_add_f32 v[158:159], v[158:159], v[60:61]
    s_waitcnt vmcnt(1)
    v_lshlrev_b32 v60, 16, v128
    v_and_b32 v61, 0xffff0000, v128
    v_pk_add_f32 v[64:65], v[64:65], v[60:61]
    v_lshlrev_b32 v60, 16, v129
    v_and_b32 v61, 0xffff0000, v129
    v_pk_add_f32 v[66:67], v[66:67], v[60:61]
    v_lshlrev_b32 v60, 16, v130
    v_and_b32 v61, 0xffff0000, v130
    v_pk_add_f32 v[68:69], v[68:69], v[60:61]
    v_lshlrev_b32 v60, 16, v131
    v_and_b32 v61, 0xffff0000, v131
    v_pk_add_f32 v[70:71], v[70:71], v[60:61]
    s_waitcnt vmcnt(0)
    v_lshlrev_b32 v60, 16, v132
    v_and_b32 v61, 0xffff0000, v132
    v_pk_add_f32 v[152:153], v[152:153], v[60:61]
    v_lshlrev_b32 v60, 16, v133
    v_and_b32 v61, 0xffff0000, v133
    v_pk_add_f32 v[154:155], v[154:155], v[60:61]
    v_lshlrev_b32 v60, 16, v134
    v_and_b32 v61, 0xffff0000, v134
    v_pk_add_f32 v[156:157], v[156:157], v[60:61]
    v_lshlrev_b32 v60, 16, v135
    v_and_b32 v61, 0xffff0000, v135
    v_pk_add_f32 v[158:159], v[158:159], v[60:61]
    v_cvt_pk_bf16_f32 v144, v64, v65
    v_cvt_pk_bf16_f32 v145, v66, v67
    v_cvt_pk_bf16_f32 v146, v68, v69
    v_cvt_pk_bf16_f32 v147, v70, v71
    ds_bpermute_b32 v144, v21, v144
    ds_bpermute_b32 v145, v21, v145
    ds_bpermute_b32 v146, v21, v146
    ds_bpermute_b32 v147, v21, v147
    v_cvt_pk_bf16_f32 v148, v152, v153
    v_cvt_pk_bf16_f32 v149, v154, v155
    v_cvt_pk_bf16_f32 v150, v156, v157
    v_cvt_pk_bf16_f32 v151, v158, v159
    ds_bpermute_b32 v148, v21, v148
    ds_bpermute_b32 v149, v21, v149
    ds_bpermute_b32 v150, v21, v150
    ds_bpermute_b32 v151, v21, v151
    s_lshl_b32 s57, s45, 7
    s_add_u32 s57, s57, s15
    s_waitcnt lgkmcnt(4)
    buffer_store_dwordx2 v[144:145], v23, s[40:43], s57 offen
    buffer_store_dwordx2 v[146:147], v23, s[40:43], s57 offen offset:32
    s_add_u32 s57, s57, 36864
    s_waitcnt lgkmcnt(0)
    buffer_store_dwordx2 v[148:149], v23, s[40:43], s57 offen
    buffer_store_dwordx2 v[150:151], v23, s[40:43], s57 offen offset:32
    s_endpgm
L_compute:
    v_lshrrev_b32 v1, 4, v0
    v_and_b32 v2, 15, v0
    v_lshrrev_b32 v237, 2, v0
    v_and_b32 v3, 3, v0
    v_lshlrev_b32 v238, 3, v3
    v_lshlrev_b32 v236, 4, v0
    s_lshl_b32 s51, s3, 8
    v_lshl_add_u32 v4, v237, 10, v238
    v_add_u32 v4, s51, v4
    v_and_b32 v5, 7, v237
    v_xor_b32 v6, 0, v5
    v_lshl_add_u32 v224, v6, 5, v4
    v_xor_b32 v6, 1, v5
    v_lshl_add_u32 v225, v6, 5, v4
    v_xor_b32 v6, 2, v5
    v_lshl_add_u32 v226, v6, 5, v4
    v_xor_b32 v6, 3, v5
    v_lshl_add_u32 v227, v6, 5, v4
    v_xor_b32 v6, 4, v5
    v_lshl_add_u32 v228, v6, 5, v4
    v_xor_b32 v6, 5, v5
    v_lshl_add_u32 v229, v6, 5, v4
    v_xor_b32 v6, 6, v5
    v_lshl_add_u32 v230, v6, 5, v4
    v_xor_b32 v6, 7, v5
    v_lshl_add_u32 v231, v6, 5, v4
    v_lshrrev_b32 v4, 3, v2
    v_lshlrev_b32 v4, 10, v4
    v_and_b32 v5, 7, v2
    v_lshl_add_u32 v4, v5, 7, v4
    v_and_b32 v5, 1, v1
    v_lshlrev_b32 v7, 3, v5
    v_add_u32 v4, v4, v7
    v_add_u32 v4, 90112, v4
    v_lshrrev_b32 v8, 1, v1
    v_lshrrev_b32 v5, 1, v2
    v_xor_b32 v5, v5, v8
    v_xor_b32 v6, 0, v5
    v_lshl_add_u32 v232, v6, 4, v4
    v_xor_b32 v6, 2, v5
    v_lshl_add_u32 v233, v6, 4, v4
    v_xor_b32 v6, 4, v5
    v_lshl_add_u32 v234, v6, 4, v4
    v_xor_b32 v6, 6, v5
    v_lshl_add_u32 v235, v6, 4, v4
    s_lshl_b32 s51, s3, 14
    s_add_u32 s52, s51, 65536
    v_lshl_add_u32 v4, v2, 8, v7
    v_add_u32 v4, s52, v4
    v_xor_b32 v5, v2, v8
    v_xor_b32 v6, 0, v5
    v_lshl_add_u32 v240, v6, 4, v4
    v_xor_b32 v6, 2, v5
    v_lshl_add_u32 v241, v6, 4, v4
    v_xor_b32 v6, 4, v5
    v_lshl_add_u32 v242, v6, 4, v4
    v_xor_b32 v6, 6, v5
    v_lshl_add_u32 v243, v6, 4, v4
    v_xor_b32 v6, 8, v5
    v_lshl_add_u32 v244, v6, 4, v4
    v_xor_b32 v6, 10, v5
    v_lshl_add_u32 v245, v6, 4, v4
    v_xor_b32 v6, 12, v5
    v_lshl_add_u32 v246, v6, 4, v4
    v_xor_b32 v6, 14, v5
    v_lshl_add_u32 v247, v6, 4, v4
    s_add_u32 s52, s51, 131072
    s_cmp_ge_u32 s3, 2
    s_cselect_b32 s53, 163840, 0
    s_sub_u32 s52, s52, s53
    s_lshl_b32 s53, s50, 3
    s_add_u32 s53, s53, s48
    s_mul_i32 s53, s53, 73728
    s_waitcnt lgkmcnt(0)
    s_add_u32 s32, s28, s53
    s_addc_u32 s33, s29, 0
    s_mov_b32 s34, 73728
    s_mov_b32 s35, 0x20000
    v_mov_b32 v0, 0
    v_mov_b32 v1, 0
    v_mov_b32 v2, 0
    v_mov_b32 v3, 0
    v_mov_b32 v4, 0
    v_mov_b32 v5, 0
    v_mov_b32 v6, 0
    v_mov_b32 v7, 0
    v_mov_b32 v8, 0
    v_mov_b32 v9, 0
    v_mov_b32 v10, 0
    v_mov_b32 v11, 0
    v_mov_b32 v12, 0
    v_mov_b32 v13, 0
    v_mov_b32 v14, 0
    v_mov_b32 v15, 0
    v_mov_b32 v16, 0
    v_mov_b32 v17, 0
    v_mov_b32 v18, 0
    v_mov_b32 v19, 0
    v_mov_b32 v20, 0
    v_mov_b32 v21, 0
    v_mov_b32 v22, 0
    v_mov_b32 v23, 0
    v_mov_b32 v24, 0
    v_mov_b32 v25, 0
    v_mov_b32 v26, 0
    v_mov_b32 v27, 0
    v_mov_b32 v28, 0
    v_mov_b32 v29, 0
    v_mov_b32 v30, 0
    v_mov_b32 v31, 0
    v_mov_b32 v32, 0
    v_mov_b32 v33, 0
    v_mov_b32 v34, 0
    v_mov_b32 v35, 0
    v_mov_b32 v36, 0
    v_mov_b32 v37, 0
    v_mov_b32 v38, 0
    v_mov_b32 v39, 0
    v_mov_b32 v40, 0
    v_mov_b32 v41, 0
    v_mov_b32 v42, 0
    v_mov_b32 v43, 0
    v_mov_b32 v44, 0
    v_mov_b32 v45, 0
    v_mov_b32 v46, 0
    v_mov_b32 v47, 0
    v_mov_b32 v48, 0
    v_mov_b32 v49, 0
    v_mov_b32 v50, 0
    v_mov_b32 v51, 0
    v_mov_b32 v52, 0
    v_mov_b32 v53, 0
    v_mov_b32 v54, 0
    v_mov_b32 v55, 0
    v_mov_b32 v56, 0
    v_mov_b32 v57, 0
    v_mov_b32 v58, 0
    v_mov_b32 v59, 0
    v_mov_b32 v60, 0
    v_mov_b32 v61, 0
    v_mov_b32 v62, 0
    v_mov_b32 v63, 0
    v_mov_b32 v64, 0
    v_mov_b32 v65, 0
    v_mov_b32 v66, 0
    v_mov_b32 v67, 0
    v_mov_b32 v68, 0
    v_mov_b32 v69, 0
    v_mov_b32 v70, 0
    v_mov_b32 v71, 0
    v_mov_b32 v72, 0
    v_mov_b32 v73, 0
    v_mov_b32 v74, 0
    v_mov_b32 v75, 0
    v_mov_b32 v76, 0
    v_mov_b32 v77, 0
    v_mov_b32 v78, 0
    v_mov_b32 v79, 0
    v_mov_b32 v80, 0
    v_mov_b32 v81, 0
    v_mov_b32 v82, 0
    v_mov_b32 v83, 0
    v_mov_b32 v84, 0
    v_mov_b32 v85, 0
    v_mov_b32 v86, 0
    v_mov_b32 v87, 0
    v_mov_b32 v88, 0
    v_mov_b32 v89, 0
    v_mov_b32 v90, 0
    v_mov_b32 v91, 0
    v_mov_b32 v92, 0
    v_mov_b32 v93, 0
    v_mov_b32 v94, 0
    v_mov_b32 v95, 0
    v_mov_b32 v96, 0
    v_mov_b32 v97, 0
    v_mov_b32 v98, 0
    v_mov_b32 v99, 0
    v_mov_b32 v100, 0
    v_mov_b32 v101, 0
    v_mov_b32 v102, 0
    v_mov_b32 v103, 0
    v_mov_b32 v104, 0
    v_mov_b32 v105, 0
    v_mov_b32 v106, 0
    v_mov_b32 v107, 0
    v_mov_b32 v108, 0
    v_mov_b32 v109, 0
    v_mov_b32 v110, 0
    v_mov_b32 v111, 0
    v_mov_b32 v112, 0
    v_mov_b32 v113, 0
    v_mov_b32 v114, 0
    v_mov_b32 v115, 0
    v_mov_b32 v116, 0
    v_mov_b32 v117, 0
    v_mov_b32 v118, 0
    v_mov_b32 v119, 0
    v_mov_b32 v120, 0
    v_mov_b32 v121, 0
    v_mov_b32 v122, 0
    v_mov_b32 v123, 0
    v_mov_b32 v124, 0
    v_mov_b32 v125, 0
    v_mov_b32 v126, 0
    v_mov_b32 v127, 0
    s_barrier
    ds_read_b64 v[160:161], v232 offset:0
    ds_read_b64 v[164:165], v232 offset:2048
    ds_read_b64 v[168:169], v232 offset:4096
    ds_read_b64 v[172:173], v232 offset:6144
    ds_read_b64_tr_b16 v[128:129], v224 offset:0
    ds_read_b64_tr_b16 v[132:133], v225 offset:0
    ds_read_b64_tr_b16 v[136:137], v226 offset:0
    ds_read_b64_tr_b16 v[140:141], v227 offset:0
    ds_read_b64_tr_b16 v[144:145], v228 offset:0
    ds_read_b64_tr_b16 v[148:149], v229 offset:0
    ds_read_b64_tr_b16 v[152:153], v230 offset:0
    ds_read_b64_tr_b16 v[156:157], v231 offset:0
    s_mov_b32 s54, 9
    s_waitcnt lgkmcnt(0)
    s_barrier
    ds_read_b64 v[162:163], v233 offset:0
    ds_read_b64 v[166:167], v233 offset:2048
    ds_read_b64 v[170:171], v233 offset:4096
    ds_read_b64 v[174:175], v233 offset:6144
    ds_read_b64_tr_b16 v[130:131], v224 offset:16384
    ds_read_b64_tr_b16 v[134:135], v225 offset:16384
    ds_read_b64_tr_b16 v[138:139], v226 offset:16384
    ds_read_b64_tr_b16 v[142:143], v227 offset:16384
    ds_read_b64_tr_b16 v[146:147], v228 offset:16384
    ds_read_b64_tr_b16 v[150:151], v229 offset:16384
    ds_read_b64_tr_b16 v[154:155], v230 offset:16384
    ds_read_b64_tr_b16 v[158:159], v231 offset:16384
    s_waitcnt lgkmcnt(0)
L_g1_loop:
    s_barrier
    v_mfma_f32_16x16x32_bf16 v[0:3], v[128:131], v[160:163], v[0:3]
    ds_read_b64 v[208:209], v234 offset:0
    v_mfma_f32_16x16x32_bf16 v[4:7], v[128:131], v[164:167], v[4:7]
    ds_read_b64 v[212:213], v234 offset:2048
    v_mfma_f32_16x16x32_bf16 v[8:11], v[128:131], v[168:171], v[8:11]
    ds_read_b64 v[216:217], v234 offset:4096
    v_mfma_f32_16x16x32_bf16 v[12:15], v[128:131], v[172:175], v[12:15]
    ds_read_b64 v[220:221], v234 offset:6144
    v_mfma_f32_16x16x32_bf16 v[28:31], v[132:135], v[172:175], v[28:31]
    ds_read_b64_tr_b16 v[176:177], v224 offset:32768
    v_mfma_f32_16x16x32_bf16 v[24:27], v[132:135], v[168:171], v[24:27]
    ds_read_b64_tr_b16 v[180:181], v225 offset:32768
    v_mfma_f32_16x16x32_bf16 v[20:23], v[132:135], v[164:167], v[20:23]
    ds_read_b64_tr_b16 v[184:185], v226 offset:32768
    v_mfma_f32_16x16x32_bf16 v[16:19], v[132:135], v[160:163], v[16:19]
    ds_read_b64_tr_b16 v[188:189], v227 offset:32768
    v_mfma_f32_16x16x32_bf16 v[32:35], v[136:139], v[160:163], v[32:35]
    ds_read_b64_tr_b16 v[192:193], v228 offset:32768
    v_mfma_f32_16x16x32_bf16 v[36:39], v[136:139], v[164:167], v[36:39]
    ds_read_b64_tr_b16 v[196:197], v229 offset:32768
    v_mfma_f32_16x16x32_bf16 v[40:43], v[136:139], v[168:171], v[40:43]
    ds_read_b64_tr_b16 v[200:201], v230 offset:32768
    v_mfma_f32_16x16x32_bf16 v[44:47], v[136:139], v[172:175], v[44:47]
    ds_read_b64_tr_b16 v[204:205], v231 offset:32768
    v_mfma_f32_16x16x32_bf16 v[60:63], v[140:143], v[172:175], v[60:63]
    v_mfma_f32_16x16x32_bf16 v[56:59], v[140:143], v[168:171], v[56:59]
    v_mfma_f32_16x16x32_bf16 v[52:55], v[140:143], v[164:167], v[52:55]
    s_waitcnt lgkmcnt(0)
    v_mfma_f32_16x16x32_bf16 v[48:51], v[140:143], v[160:163], v[48:51]
    s_barrier
    v_mfma_f32_16x16x32_bf16 v[64:67], v[144:147], v[160:163], v[64:67]
    ds_read_b64 v[210:211], v235 offset:0
    v_mfma_f32_16x16x32_bf16 v[68:71], v[144:147], v[164:167], v[68:71]
    ds_read_b64 v[214:215], v235 offset:2048
    v_mfma_f32_16x16x32_bf16 v[72:75], v[144:147], v[168:171], v[72:75]
    ds_read_b64 v[218:219], v235 offset:4096
    v_mfma_f32_16x16x32_bf16 v[76:79], v[144:147], v[172:175], v[76:79]
    ds_read_b64 v[222:223], v235 offset:6144
    v_mfma_f32_16x16x32_bf16 v[92:95], v[148:151], v[172:175], v[92:95]
    ds_read_b64_tr_b16 v[178:179], v224 offset:49152
    v_mfma_f32_16x16x32_bf16 v[88:91], v[148:151], v[168:171], v[88:91]
    ds_read_b64_tr_b16 v[182:183], v225 offset:49152
    v_mfma_f32_16x16x32_bf16 v[84:87], v[148:151], v[164:167], v[84:87]
    ds_read_b64_tr_b16 v[186:187], v226 offset:49152
    v_mfma_f32_16x16x32_bf16 v[80:83], v[148:151], v[160:163], v[80:83]
    ds_read_b64_tr_b16 v[190:191], v227 offset:49152
    v_mfma_f32_16x16x32_bf16 v[96:99], v[152:155], v[160:163], v[96:99]
    ds_read_b64_tr_b16 v[194:195], v228 offset:49152
    v_mfma_f32_16x16x32_bf16 v[100:103], v[152:155], v[164:167], v[100:103]
    ds_read_b64_tr_b16 v[198:199], v229 offset:49152
    v_mfma_f32_16x16x32_bf16 v[104:107], v[152:155], v[168:171], v[104:107]
    ds_read_b64_tr_b16 v[202:203], v230 offset:49152
    v_mfma_f32_16x16x32_bf16 v[108:111], v[152:155], v[172:175], v[108:111]
    ds_read_b64_tr_b16 v[206:207], v231 offset:49152
    v_mfma_f32_16x16x32_bf16 v[124:127], v[156:159], v[172:175], v[124:127]
    s_sub_u32 s54, s54, 1
    v_mfma_f32_16x16x32_bf16 v[120:123], v[156:159], v[168:171], v[120:123]
    v_add_u32 v232, 8192, v232
    v_mfma_f32_16x16x32_bf16 v[116:119], v[156:159], v[164:167], v[116:119]
    v_add_u32 v233, 8192, v233
    s_waitcnt lgkmcnt(0)
    v_mfma_f32_16x16x32_bf16 v[112:115], v[156:159], v[160:163], v[112:115]
    s_cmp_eq_u32 s54, 0
    s_cbranch_scc1 L_g1_last
    s_barrier
    v_mfma_f32_16x16x32_bf16 v[0:3], v[176:179], v[208:211], v[0:3]
    ds_read_b64 v[160:161], v232 offset:0
    v_mfma_f32_16x16x32_bf16 v[4:7], v[176:179], v[212:215], v[4:7]
    ds_read_b64 v[164:165], v232 offset:2048
    v_mfma_f32_16x16x32_bf16 v[8:11], v[176:179], v[216:219], v[8:11]
    ds_read_b64 v[168:169], v232 offset:4096
    v_mfma_f32_16x16x32_bf16 v[12:15], v[176:179], v[220:223], v[12:15]
    ds_read_b64 v[172:173], v232 offset:6144
    v_mfma_f32_16x16x32_bf16 v[28:31], v[180:183], v[220:223], v[28:31]
    ds_read_b64_tr_b16 v[128:129], v224 offset:0
    v_mfma_f32_16x16x32_bf16 v[24:27], v[180:183], v[216:219], v[24:27]
    ds_read_b64_tr_b16 v[132:133], v225 offset:0
    v_mfma_f32_16x16x32_bf16 v[20:23], v[180:183], v[212:215], v[20:23]
    ds_read_b64_tr_b16 v[136:137], v226 offset:0
    v_mfma_f32_16x16x32_bf16 v[16:19], v[180:183], v[208:211], v[16:19]
    ds_read_b64_tr_b16 v[140:141], v227 offset:0
    v_mfma_f32_16x16x32_bf16 v[32:35], v[184:187], v[208:211], v[32:35]
    ds_read_b64_tr_b16 v[144:145], v228 offset:0
    v_mfma_f32_16x16x32_bf16 v[36:39], v[184:187], v[212:215], v[36:39]
    ds_read_b64_tr_b16 v[148:149], v229 offset:0
    v_mfma_f32_16x16x32_bf16 v[40:43], v[184:187], v[216:219], v[40:43]
    ds_read_b64_tr_b16 v[152:153], v230 offset:0
    v_mfma_f32_16x16x32_bf16 v[44:47], v[184:187], v[220:223], v[44:47]
    ds_read_b64_tr_b16 v[156:157], v231 offset:0
    v_mfma_f32_16x16x32_bf16 v[60:63], v[188:191], v[220:223], v[60:63]
    v_add_u32 v234, 8192, v234
    v_mfma_f32_16x16x32_bf16 v[56:59], v[188:191], v[216:219], v[56:59]
    v_add_u32 v235, 8192, v235
    v_mfma_f32_16x16x32_bf16 v[52:55], v[188:191], v[212:215], v[52:55]
    s_waitcnt lgkmcnt(0)
    v_mfma_f32_16x16x32_bf16 v[48:51], v[188:191], v[208:211], v[48:51]
    s_barrier
    v_mfma_f32_16x16x32_bf16 v[64:67], v[192:195], v[208:211], v[64:67]
    ds_read_b64 v[162:163], v233 offset:0
    v_mfma_f32_16x16x32_bf16 v[68:71], v[192:195], v[212:215], v[68:71]
    ds_read_b64 v[166:167], v233 offset:2048
    v_mfma_f32_16x16x32_bf16 v[72:75], v[192:195], v[216:219], v[72:75]
    ds_read_b64 v[170:171], v233 offset:4096
    v_mfma_f32_16x16x32_bf16 v[76:79], v[192:195], v[220:223], v[76:79]
    ds_read_b64 v[174:175], v233 offset:6144
    v_mfma_f32_16x16x32_bf16 v[92:95], v[196:199], v[220:223], v[92:95]
    ds_read_b64_tr_b16 v[130:131], v224 offset:16384
    v_mfma_f32_16x16x32_bf16 v[88:91], v[196:199], v[216:219], v[88:91]
    ds_read_b64_tr_b16 v[134:135], v225 offset:16384
    v_mfma_f32_16x16x32_bf16 v[84:87], v[196:199], v[212:215], v[84:87]
    ds_read_b64_tr_b16 v[138:139], v226 offset:16384
    v_mfma_f32_16x16x32_bf16 v[80:83], v[196:199], v[208:211], v[80:83]
    ds_read_b64_tr_b16 v[142:143], v227 offset:16384
    v_mfma_f32_16x16x32_bf16 v[96:99], v[200:203], v[208:211], v[96:99]
    ds_read_b64_tr_b16 v[146:147], v228 offset:16384
    v_mfma_f32_16x16x32_bf16 v[100:103], v[200:203], v[212:215], v[100:103]
    ds_read_b64_tr_b16 v[150:151], v229 offset:16384
    v_mfma_f32_16x16x32_bf16 v[104:107], v[200:203], v[216:219], v[104:107]
    ds_read_b64_tr_b16 v[154:155], v230 offset:16384
    v_mfma_f32_16x16x32_bf16 v[108:111], v[200:203], v[220:223], v[108:111]
    ds_read_b64_tr_b16 v[158:159], v231 offset:16384
    v_mfma_f32_16x16x32_bf16 v[124:127], v[204:207], v[220:223], v[124:127]
    v_mfma_f32_16x16x32_bf16 v[120:123], v[204:207], v[216:219], v[120:123]
    v_mfma_f32_16x16x32_bf16 v[116:119], v[204:207], v[212:215], v[116:119]
    s_waitcnt lgkmcnt(0)
    v_mfma_f32_16x16x32_bf16 v[112:115], v[204:207], v[208:211], v[112:115]
    s_branch L_g1_loop
L_g1_last:
    s_barrier
    v_mfma_f32_16x16x32_bf16 v[0:3], v[176:179], v[208:211], v[0:3]
    ds_read_b64 v[128:129], v240 offset:0
    ds_read_b64 v[130:131], v241 offset:0
    v_mfma_f32_16x16x32_bf16 v[4:7], v[176:179], v[212:215], v[4:7]
    ds_read_b64 v[132:133], v240 offset:4096
    ds_read_b64 v[134:135], v241 offset:4096
    v_mfma_f32_16x16x32_bf16 v[8:11], v[176:179], v[216:219], v[8:11]
    ds_read_b64 v[136:137], v240 offset:8192
    ds_read_b64 v[138:139], v241 offset:8192
    v_mfma_f32_16x16x32_bf16 v[12:15], v[176:179], v[220:223], v[12:15]
    ds_read_b64 v[140:141], v240 offset:12288
    ds_read_b64 v[142:143], v241 offset:12288
    v_mfma_f32_16x16x32_bf16 v[28:31], v[180:183], v[220:223], v[28:31]
    ds_read_b64 v[144:145], v242 offset:0
    ds_read_b64 v[146:147], v243 offset:0
    v_mfma_f32_16x16x32_bf16 v[24:27], v[180:183], v[216:219], v[24:27]
    ds_read_b64 v[148:149], v242 offset:4096
    ds_read_b64 v[150:151], v243 offset:4096
    v_mfma_f32_16x16x32_bf16 v[20:23], v[180:183], v[212:215], v[20:23]
    ds_read_b64 v[152:153], v242 offset:8192
    ds_read_b64 v[154:155], v243 offset:8192
    v_mfma_f32_16x16x32_bf16 v[16:19], v[180:183], v[208:211], v[16:19]
    ds_read_b64 v[156:157], v242 offset:12288
    ds_read_b64 v[158:159], v243 offset:12288
    v_mfma_f32_16x16x32_bf16 v[32:35], v[184:187], v[208:211], v[32:35]
    ds_read_b64 v[160:161], v244 offset:0
    ds_read_b64 v[162:163], v245 offset:0
    v_mfma_f32_16x16x32_bf16 v[36:39], v[184:187], v[212:215], v[36:39]
    ds_read_b64 v[164:165], v244 offset:4096
    ds_read_b64 v[166:167], v245 offset:4096
    v_mfma_f32_16x16x32_bf16 v[40:43], v[184:187], v[216:219], v[40:43]
    ds_read_b64 v[168:169], v244 offset:8192
    ds_read_b64 v[170:171], v245 offset:8192
    v_mfma_f32_16x16x32_bf16 v[44:47], v[184:187], v[220:223], v[44:47]
    ds_read_b64 v[172:173], v244 offset:12288
    ds_read_b64 v[174:175], v245 offset:12288
    v_mfma_f32_16x16x32_bf16 v[60:63], v[188:191], v[220:223], v[60:63]
    v_mfma_f32_16x16x32_bf16 v[56:59], v[188:191], v[216:219], v[56:59]
    v_mfma_f32_16x16x32_bf16 v[52:55], v[188:191], v[212:215], v[52:55]
    v_mfma_f32_16x16x32_bf16 v[48:51], v[188:191], v[208:211], v[48:51]
    v_mfma_f32_16x16x32_bf16 v[64:67], v[192:195], v[208:211], v[64:67]
    ds_read_b64 v[176:177], v246 offset:0
    ds_read_b64 v[178:179], v247 offset:0
    v_mfma_f32_16x16x32_bf16 v[68:71], v[192:195], v[212:215], v[68:71]
    ds_read_b64 v[180:181], v246 offset:4096
    ds_read_b64 v[182:183], v247 offset:4096
    v_mfma_f32_16x16x32_bf16 v[72:75], v[192:195], v[216:219], v[72:75]
    ds_read_b64 v[184:185], v246 offset:8192
    ds_read_b64 v[186:187], v247 offset:8192
    v_mfma_f32_16x16x32_bf16 v[76:79], v[192:195], v[220:223], v[76:79]
    ds_read_b64 v[188:189], v246 offset:12288
    ds_read_b64 v[190:191], v247 offset:12288
    v_mfma_f32_16x16x32_bf16 v[92:95], v[196:199], v[220:223], v[92:95]
    v_cvt_pk_bf16_f32 v0, v0, v1
    v_cvt_pk_bf16_f32 v1, v2, v3
    v_mfma_f32_16x16x32_bf16 v[88:91], v[196:199], v[216:219], v[88:91]
    v_cvt_pk_bf16_f32 v2, v16, v17
    v_cvt_pk_bf16_f32 v3, v18, v19
    v_mfma_f32_16x16x32_bf16 v[84:87], v[196:199], v[212:215], v[84:87]
    v_cvt_pk_bf16_f32 v4, v4, v5
    v_cvt_pk_bf16_f32 v5, v6, v7
    v_mfma_f32_16x16x32_bf16 v[80:83], v[196:199], v[208:211], v[80:83]
    v_cvt_pk_bf16_f32 v6, v20, v21
    v_cvt_pk_bf16_f32 v7, v22, v23
    v_mfma_f32_16x16x32_bf16 v[96:99], v[200:203], v[208:211], v[96:99]
    v_cvt_pk_bf16_f32 v8, v8, v9
    v_cvt_pk_bf16_f32 v9, v10, v11
    v_mfma_f32_16x16x32_bf16 v[100:103], v[200:203], v[212:215], v[100:103]
    v_cvt_pk_bf16_f32 v10, v24, v25
    v_cvt_pk_bf16_f32 v11, v26, v27
    v_mfma_f32_16x16x32_bf16 v[104:107], v[200:203], v[216:219], v[104:107]
    v_cvt_pk_bf16_f32 v12, v12, v13
    v_cvt_pk_bf16_f32 v13, v14, v15
    v_mfma_f32_16x16x32_bf16 v[108:111], v[200:203], v[220:223], v[108:111]
    v_cvt_pk_bf16_f32 v14, v28, v29
    v_cvt_pk_bf16_f32 v15, v30, v31
    v_mfma_f32_16x16x32_bf16 v[124:127], v[204:207], v[220:223], v[124:127]
    v_cvt_pk_bf16_f32 v16, v32, v33
    v_cvt_pk_bf16_f32 v17, v34, v35
    v_mfma_f32_16x16x32_bf16 v[120:123], v[204:207], v[216:219], v[120:123]
    v_cvt_pk_bf16_f32 v18, v48, v49
    v_cvt_pk_bf16_f32 v19, v50, v51
    v_mfma_f32_16x16x32_bf16 v[116:119], v[204:207], v[212:215], v[116:119]
    v_cvt_pk_bf16_f32 v20, v36, v37
    v_cvt_pk_bf16_f32 v21, v38, v39
    v_mfma_f32_16x16x32_bf16 v[112:115], v[204:207], v[208:211], v[112:115]
    v_cvt_pk_bf16_f32 v22, v52, v53
    v_cvt_pk_bf16_f32 v23, v54, v55
    v_cvt_pk_bf16_f32 v24, v40, v41
    v_cvt_pk_bf16_f32 v25, v42, v43
    v_cvt_pk_bf16_f32 v26, v56, v57
    v_cvt_pk_bf16_f32 v27, v58, v59
    v_cvt_pk_bf16_f32 v28, v44, v45
    v_cvt_pk_bf16_f32 v29, v46, v47
    v_cvt_pk_bf16_f32 v30, v60, v61
    v_cvt_pk_bf16_f32 v31, v62, v63
    s_waitcnt lgkmcnt(8)
    v_mfma_f32_16x16x32_bf16 v[32:35], v[128:131], v[0:3], 0
    v_cvt_pk_bf16_f32 v64, v64, v65
    v_cvt_pk_bf16_f32 v65, v66, v67
    v_mfma_f32_16x16x32_bf16 v[36:39], v[128:131], v[4:7], 0
    v_cvt_pk_bf16_f32 v66, v80, v81
    v_cvt_pk_bf16_f32 v67, v82, v83
    v_mfma_f32_16x16x32_bf16 v[40:43], v[128:131], v[8:11], 0
    v_cvt_pk_bf16_f32 v68, v68, v69
    v_cvt_pk_bf16_f32 v69, v70, v71
    v_mfma_f32_16x16x32_bf16 v[44:47], v[128:131], v[12:15], 0
    v_cvt_pk_bf16_f32 v70, v84, v85
    v_cvt_pk_bf16_f32 v71, v86, v87
    v_mfma_f32_16x16x32_bf16 v[60:63], v[132:135], v[12:15], 0
    v_cvt_pk_bf16_f32 v72, v72, v73
    v_cvt_pk_bf16_f32 v73, v74, v75
    v_mfma_f32_16x16x32_bf16 v[56:59], v[132:135], v[8:11], 0
    v_cvt_pk_bf16_f32 v74, v88, v89
    v_cvt_pk_bf16_f32 v75, v90, v91
    v_mfma_f32_16x16x32_bf16 v[52:55], v[132:135], v[4:7], 0
    v_cvt_pk_bf16_f32 v76, v76, v77
    v_cvt_pk_bf16_f32 v77, v78, v79
    v_mfma_f32_16x16x32_bf16 v[48:51], v[132:135], v[0:3], 0
    v_cvt_pk_bf16_f32 v78, v92, v93
    v_cvt_pk_bf16_f32 v79, v94, v95
    v_mfma_f32_16x16x32_bf16 v[192:195], v[136:139], v[0:3], 0
    v_cvt_pk_bf16_f32 v80, v96, v97
    v_cvt_pk_bf16_f32 v81, v98, v99
    v_mfma_f32_16x16x32_bf16 v[196:199], v[136:139], v[4:7], 0
    v_cvt_pk_bf16_f32 v82, v112, v113
    v_cvt_pk_bf16_f32 v83, v114, v115
    v_mfma_f32_16x16x32_bf16 v[200:203], v[136:139], v[8:11], 0
    v_cvt_pk_bf16_f32 v84, v100, v101
    v_cvt_pk_bf16_f32 v85, v102, v103
    v_mfma_f32_16x16x32_bf16 v[204:207], v[136:139], v[12:15], 0
    v_cvt_pk_bf16_f32 v86, v116, v117
    v_cvt_pk_bf16_f32 v87, v118, v119
    v_mfma_f32_16x16x32_bf16 v[220:223], v[140:143], v[12:15], 0
    v_cvt_pk_bf16_f32 v88, v104, v105
    v_cvt_pk_bf16_f32 v89, v106, v107
    v_mfma_f32_16x16x32_bf16 v[216:219], v[140:143], v[8:11], 0
    v_cvt_pk_bf16_f32 v90, v120, v121
    v_cvt_pk_bf16_f32 v91, v122, v123
    v_mfma_f32_16x16x32_bf16 v[212:215], v[140:143], v[4:7], 0
    v_cvt_pk_bf16_f32 v92, v108, v109
    v_cvt_pk_bf16_f32 v93, v110, v111
    v_mfma_f32_16x16x32_bf16 v[208:211], v[140:143], v[0:3], 0
    v_cvt_pk_bf16_f32 v94, v124, v125
    v_cvt_pk_bf16_f32 v95, v126, v127
    v_mfma_f32_16x16x32_bf16 v[32:35], v[144:147], v[16:19], v[32:35]
    v_lshl_add_u32 v248, v237, 8, v238
    v_add_u32 v248, s52, v248
    v_mfma_f32_16x16x32_bf16 v[36:39], v[144:147], v[20:23], v[36:39]
    v_and_b32 v249, 7, v237
    v_xor_b32 v239, 0, v249
    v_mfma_f32_16x16x32_bf16 v[40:43], v[144:147], v[24:27], v[40:43]
    v_lshl_add_u32 v224, v239, 5, v248
    v_xor_b32 v239, 1, v249
    v_mfma_f32_16x16x32_bf16 v[44:47], v[144:147], v[28:31], v[44:47]
    v_lshl_add_u32 v225, v239, 5, v248
    v_xor_b32 v239, 2, v249
    v_mfma_f32_16x16x32_bf16 v[60:63], v[148:151], v[28:31], v[60:63]
    v_lshl_add_u32 v226, v239, 5, v248
    v_xor_b32 v239, 3, v249
    v_mfma_f32_16x16x32_bf16 v[56:59], v[148:151], v[24:27], v[56:59]
    v_lshl_add_u32 v227, v239, 5, v248
    v_xor_b32 v239, 4, v249
    v_mfma_f32_16x16x32_bf16 v[52:55], v[148:151], v[20:23], v[52:55]
    v_lshl_add_u32 v228, v239, 5, v248
    v_xor_b32 v239, 5, v249
    v_mfma_f32_16x16x32_bf16 v[48:51], v[148:151], v[16:19], v[48:51]
    v_lshl_add_u32 v229, v239, 5, v248
    v_xor_b32 v239, 6, v249
    v_mfma_f32_16x16x32_bf16 v[192:195], v[152:155], v[16:19], v[192:195]
    v_lshl_add_u32 v230, v239, 5, v248
    v_xor_b32 v239, 7, v249
    v_mfma_f32_16x16x32_bf16 v[196:199], v[152:155], v[20:23], v[196:199]
    v_lshl_add_u32 v231, v239, 5, v248
    s_mov_b32 s56, 0x3e0293ee
    v_mfma_f32_16x16x32_bf16 v[200:203], v[152:155], v[24:27], v[200:203]
    s_mov_b32 s57, 0x3e0293ee
    s_waitcnt lgkmcnt(0)
    v_mfma_f32_16x16x32_bf16 v[204:207], v[152:155], v[28:31], v[204:207]
    v_mfma_f32_16x16x32_bf16 v[220:223], v[156:159], v[28:31], v[220:223]
    v_mfma_f32_16x16x32_bf16 v[216:219], v[156:159], v[24:27], v[216:219]
    v_mfma_f32_16x16x32_bf16 v[212:215], v[156:159], v[20:23], v[212:215]
    v_mfma_f32_16x16x32_bf16 v[208:211], v[156:159], v[16:19], v[208:211]
    v_mfma_f32_16x16x32_bf16 v[32:35], v[160:163], v[64:67], v[32:35]
    v_mfma_f32_16x16x32_bf16 v[48:51], v[164:167], v[64:67], v[48:51]
    v_mfma_f32_16x16x32_bf16 v[192:195], v[168:171], v[64:67], v[192:195]
    v_mfma_f32_16x16x32_bf16 v[208:211], v[172:175], v[64:67], v[208:211]
    v_mfma_f32_16x16x32_bf16 v[32:35], v[176:179], v[80:83], v[32:35]
    v_mfma_f32_16x16x32_bf16 v[48:51], v[180:183], v[80:83], v[48:51]
    v_mfma_f32_16x16x32_bf16 v[192:195], v[184:187], v[80:83], v[192:195]
    v_mfma_f32_16x16x32_bf16 v[208:211], v[188:191], v[80:83], v[208:211]
    v_mfma_f32_16x16x32_bf16 v[36:39], v[160:163], v[68:71], v[36:39]
    v_mfma_f32_16x16x32_bf16 v[52:55], v[164:167], v[68:71], v[52:55]
    v_mfma_f32_16x16x32_bf16 v[196:199], v[168:171], v[68:71], v[196:199]
    v_mfma_f32_16x16x32_bf16 v[212:215], v[172:175], v[68:71], v[212:215]
    v_mfma_f32_16x16x32_bf16 v[36:39], v[176:179], v[84:87], v[36:39]
    v_max3_f32 v240, v32, v33, v34
    v_max3_f32 v240, v240, v35, v48
    v_mfma_f32_16x16x32_bf16 v[52:55], v[180:183], v[84:87], v[52:55]
    v_max3_f32 v240, v240, v49, v50
    v_max3_f32 v240, v240, v51, v192
    v_mfma_f32_16x16x32_bf16 v[196:199], v[184:187], v[84:87], v[196:199]
    v_max3_f32 v240, v240, v193, v194
    v_max3_f32 v240, v240, v195, v208
    v_mfma_f32_16x16x32_bf16 v[212:215], v[188:191], v[84:87], v[212:215]
    v_max3_f32 v240, v240, v209, v210
    v_max_f32 v240, v240, v211
    v_mfma_f32_16x16x32_bf16 v[40:43], v[160:163], v[72:75], v[40:43]
    v_mfma_f32_16x16x32_bf16 v[56:59], v[164:167], v[72:75], v[56:59]
    v_mfma_f32_16x16x32_bf16 v[200:203], v[168:171], v[72:75], v[200:203]
    v_mfma_f32_16x16x32_bf16 v[216:219], v[172:175], v[72:75], v[216:219]
    v_mfma_f32_16x16x32_bf16 v[40:43], v[176:179], v[88:91], v[40:43]
    v_max3_f32 v242, v36, v37, v38
    v_max3_f32 v242, v242, v39, v52
    v_mfma_f32_16x16x32_bf16 v[56:59], v[180:183], v[88:91], v[56:59]
    v_max3_f32 v242, v242, v53, v54
    v_max3_f32 v242, v242, v55, v196
    v_mfma_f32_16x16x32_bf16 v[200:203], v[184:187], v[88:91], v[200:203]
    v_max3_f32 v242, v242, v197, v198
    v_max3_f32 v242, v242, v199, v212
    v_mfma_f32_16x16x32_bf16 v[216:219], v[188:191], v[88:91], v[216:219]
    v_max3_f32 v242, v242, v213, v214
    v_max_f32 v242, v242, v215
    v_mfma_f32_16x16x32_bf16 v[44:47], v[160:163], v[76:79], v[44:47]
    v_mfma_f32_16x16x32_bf16 v[60:63], v[164:167], v[76:79], v[60:63]
    v_mfma_f32_16x16x32_bf16 v[204:207], v[168:171], v[76:79], v[204:207]
    v_mfma_f32_16x16x32_bf16 v[220:223], v[172:175], v[76:79], v[220:223]
    v_mfma_f32_16x16x32_bf16 v[44:47], v[176:179], v[92:95], v[44:47]
    v_max3_f32 v244, v40, v41, v42
    v_max3_f32 v244, v244, v43, v56
    v_mfma_f32_16x16x32_bf16 v[60:63], v[180:183], v[92:95], v[60:63]
    v_max3_f32 v244, v244, v57, v58
    v_max3_f32 v244, v244, v59, v200
    v_mfma_f32_16x16x32_bf16 v[204:207], v[184:187], v[92:95], v[204:207]
    v_max3_f32 v244, v244, v201, v202
    v_max3_f32 v244, v244, v203, v216
    v_mfma_f32_16x16x32_bf16 v[220:223], v[188:191], v[92:95], v[220:223]
    v_max3_f32 v244, v244, v217, v218
    v_max_f32 v244, v244, v219
    s_nop 3
    v_max3_f32 v246, v44, v45, v46
    v_max3_f32 v246, v246, v47, v60
    s_nop 1
    v_max3_f32 v246, v246, v61, v62
    v_max3_f32 v246, v246, v63, v204
    v_max3_f32 v246, v246, v205, v206
    v_max3_f32 v246, v246, v207, v220
    v_max3_f32 v246, v246, v221, v222
    v_max_f32 v246, v246, v223
    s_nop 1
    v_permlane16_swap_b32 v240, v242
    v_permlane16_swap_b32 v244, v246
    s_nop 0
    v_max_f32 v240, v240, v242
    v_max_f32 v244, v244, v246
    s_nop 1
    v_permlane32_swap_b32 v240, v244
    s_nop 1
    v_max_f32 v240, v240, v244
    v_mul_f32 v240, s56, v240
    v_mov_b32 v244, v240
    s_nop 1
    v_permlane32_swap_b32 v240, v244
    s_nop 1
    v_mov_b32 v242, v240
    v_mov_b32 v246, v244
    s_nop 1
    v_permlane16_swap_b32 v240, v242
    v_permlane16_swap_b32 v244, v246
    s_nop 1
    v_pk_fma_f32 v[32:33], v[32:33], s[56:57], v[240:241] op_sel_hi:[1,1,0] neg_lo:[0,0,1] neg_hi:[0,0,1]
    v_pk_fma_f32 v[36:37], v[36:37], s[56:57], v[242:243] op_sel_hi:[1,1,0] neg_lo:[0,0,1] neg_hi:[0,0,1]
    v_pk_fma_f32 v[40:41], v[40:41], s[56:57], v[244:245] op_sel_hi:[1,1,0] neg_lo:[0,0,1] neg_hi:[0,0,1]
    v_pk_fma_f32 v[44:45], v[44:45], s[56:57], v[246:247] op_sel_hi:[1,1,0] neg_lo:[0,0,1] neg_hi:[0,0,1]
    v_pk_fma_f32 v[34:35], v[34:35], s[56:57], v[240:241] op_sel_hi:[1,1,0] neg_lo:[0,0,1] neg_hi:[0,0,1]
    v_pk_fma_f32 v[38:39], v[38:39], s[56:57], v[242:243] op_sel_hi:[1,1,0] neg_lo:[0,0,1] neg_hi:[0,0,1]
    v_pk_fma_f32 v[42:43], v[42:43], s[56:57], v[244:245] op_sel_hi:[1,1,0] neg_lo:[0,0,1] neg_hi:[0,0,1]
    v_pk_fma_f32 v[46:47], v[46:47], s[56:57], v[246:247] op_sel_hi:[1,1,0] neg_lo:[0,0,1] neg_hi:[0,0,1]
    v_pk_fma_f32 v[48:49], v[48:49], s[56:57], v[240:241] op_sel_hi:[1,1,0] neg_lo:[0,0,1] neg_hi:[0,0,1]
    v_pk_fma_f32 v[52:53], v[52:53], s[56:57], v[242:243] op_sel_hi:[1,1,0] neg_lo:[0,0,1] neg_hi:[0,0,1]
    v_pk_fma_f32 v[56:57], v[56:57], s[56:57], v[244:245] op_sel_hi:[1,1,0] neg_lo:[0,0,1] neg_hi:[0,0,1]
    v_pk_fma_f32 v[60:61], v[60:61], s[56:57], v[246:247] op_sel_hi:[1,1,0] neg_lo:[0,0,1] neg_hi:[0,0,1]
    v_pk_fma_f32 v[50:51], v[50:51], s[56:57], v[240:241] op_sel_hi:[1,1,0] neg_lo:[0,0,1] neg_hi:[0,0,1]
    v_pk_fma_f32 v[54:55], v[54:55], s[56:57], v[242:243] op_sel_hi:[1,1,0] neg_lo:[0,0,1] neg_hi:[0,0,1]
    v_pk_fma_f32 v[58:59], v[58:59], s[56:57], v[244:245] op_sel_hi:[1,1,0] neg_lo:[0,0,1] neg_hi:[0,0,1]
    v_pk_fma_f32 v[62:63], v[62:63], s[56:57], v[246:247] op_sel_hi:[1,1,0] neg_lo:[0,0,1] neg_hi:[0,0,1]
    v_pk_fma_f32 v[192:193], v[192:193], s[56:57], v[240:241] op_sel_hi:[1,1,0] neg_lo:[0,0,1] neg_hi:[0,0,1]
    v_pk_fma_f32 v[196:197], v[196:197], s[56:57], v[242:243] op_sel_hi:[1,1,0] neg_lo:[0,0,1] neg_hi:[0,0,1]
    v_pk_fma_f32 v[200:201], v[200:201], s[56:57], v[244:245] op_sel_hi:[1,1,0] neg_lo:[0,0,1] neg_hi:[0,0,1]
    v_pk_fma_f32 v[204:205], v[204:205], s[56:57], v[246:247] op_sel_hi:[1,1,0] neg_lo:[0,0,1] neg_hi:[0,0,1]
    v_pk_fma_f32 v[194:195], v[194:195], s[56:57], v[240:241] op_sel_hi:[1,1,0] neg_lo:[0,0,1] neg_hi:[0,0,1]
    v_pk_fma_f32 v[198:199], v[198:199], s[56:57], v[242:243] op_sel_hi:[1,1,0] neg_lo:[0,0,1] neg_hi:[0,0,1]
    v_pk_fma_f32 v[202:203], v[202:203], s[56:57], v[244:245] op_sel_hi:[1,1,0] neg_lo:[0,0,1] neg_hi:[0,0,1]
    v_pk_fma_f32 v[206:207], v[206:207], s[56:57], v[246:247] op_sel_hi:[1,1,0] neg_lo:[0,0,1] neg_hi:[0,0,1]
    v_pk_fma_f32 v[208:209], v[208:209], s[56:57], v[240:241] op_sel_hi:[1,1,0] neg_lo:[0,0,1] neg_hi:[0,0,1]
    v_pk_fma_f32 v[212:213], v[212:213], s[56:57], v[242:243] op_sel_hi:[1,1,0] neg_lo:[0,0,1] neg_hi:[0,0,1]
    v_pk_fma_f32 v[216:217], v[216:217], s[56:57], v[244:245] op_sel_hi:[1,1,0] neg_lo:[0,0,1] neg_hi:[0,0,1]
    v_pk_fma_f32 v[220:221], v[220:221], s[56:57], v[246:247] op_sel_hi:[1,1,0] neg_lo:[0,0,1] neg_hi:[0,0,1]
    v_pk_fma_f32 v[210:211], v[210:211], s[56:57], v[240:241] op_sel_hi:[1,1,0] neg_lo:[0,0,1] neg_hi:[0,0,1]
    v_pk_fma_f32 v[214:215], v[214:215], s[56:57], v[242:243] op_sel_hi:[1,1,0] neg_lo:[0,0,1] neg_hi:[0,0,1]
    v_pk_fma_f32 v[218:219], v[218:219], s[56:57], v[244:245] op_sel_hi:[1,1,0] neg_lo:[0,0,1] neg_hi:[0,0,1]
    v_pk_fma_f32 v[222:223], v[222:223], s[56:57], v[246:247] op_sel_hi:[1,1,0] neg_lo:[0,0,1] neg_hi:[0,0,1]
    v_exp_f32 v32, v32
    v_exp_f32 v36, v36
    v_exp_f32 v40, v40
    v_exp_f32 v44, v44
    v_exp_f32 v33, v33
    v_exp_f32 v37, v37
    v_exp_f32 v41, v41
    v_exp_f32 v45, v45
    v_exp_f32 v34, v34
    v_exp_f32 v38, v38
    v_exp_f32 v42, v42
    v_exp_f32 v46, v46
    v_exp_f32 v35, v35
    v_exp_f32 v39, v39
    v_exp_f32 v43, v43
    v_exp_f32 v47, v47
    v_exp_f32 v48, v48
    v_exp_f32 v52, v52
    v_exp_f32 v56, v56
    v_exp_f32 v60, v60
    v_exp_f32 v49, v49
    v_exp_f32 v53, v53
    v_exp_f32 v57, v57
    v_exp_f32 v61, v61
    v_exp_f32 v50, v50
    v_exp_f32 v54, v54
    v_exp_f32 v58, v58
    v_exp_f32 v62, v62
    v_exp_f32 v51, v51
    v_exp_f32 v55, v55
    v_exp_f32 v59, v59
    v_exp_f32 v63, v63
    v_exp_f32 v192, v192
    v_exp_f32 v196, v196
    v_exp_f32 v200, v200
    v_exp_f32 v204, v204
    v_exp_f32 v193, v193
    v_exp_f32 v197, v197
    v_exp_f32 v201, v201
    v_exp_f32 v205, v205
    v_exp_f32 v194, v194
    v_exp_f32 v198, v198
    v_exp_f32 v202, v202
    v_exp_f32 v206, v206
    v_exp_f32 v195, v195
    v_exp_f32 v199, v199
    v_exp_f32 v203, v203
    v_exp_f32 v207, v207
    v_exp_f32 v208, v208
    v_exp_f32 v212, v212
    v_exp_f32 v216, v216
    v_exp_f32 v220, v220
    v_exp_f32 v209, v209
    v_exp_f32 v213, v213
    v_exp_f32 v217, v217
    v_exp_f32 v221, v221
    v_exp_f32 v210, v210
    v_exp_f32 v214, v214
    v_exp_f32 v218, v218
    v_exp_f32 v222, v222
    v_exp_f32 v211, v211
    v_exp_f32 v215, v215
    v_exp_f32 v219, v219
    v_exp_f32 v223, v223
    v_pk_add_f32 v[232:233], v[32:33], v[34:35]
    v_pk_add_f32 v[234:235], v[36:37], v[38:39]
    v_pk_add_f32 v[248:249], v[40:41], v[42:43]
    v_pk_add_f32 v[250:251], v[44:45], v[46:47]
    v_pk_add_f32 v[232:233], v[232:233], v[48:49]
    v_pk_add_f32 v[234:235], v[234:235], v[52:53]
    v_pk_add_f32 v[248:249], v[248:249], v[56:57]
    v_pk_add_f32 v[250:251], v[250:251], v[60:61]
    v_pk_add_f32 v[232:233], v[232:233], v[50:51]
    v_pk_add_f32 v[234:235], v[234:235], v[54:55]
    v_pk_add_f32 v[248:249], v[248:249], v[58:59]
    v_pk_add_f32 v[250:251], v[250:251], v[62:63]
    v_pk_add_f32 v[232:233], v[232:233], v[192:193]
    v_pk_add_f32 v[234:235], v[234:235], v[196:197]
    v_pk_add_f32 v[248:249], v[248:249], v[200:201]
    v_pk_add_f32 v[250:251], v[250:251], v[204:205]
    v_pk_add_f32 v[232:233], v[232:233], v[194:195]
    v_pk_add_f32 v[234:235], v[234:235], v[198:199]
    v_pk_add_f32 v[248:249], v[248:249], v[202:203]
    v_pk_add_f32 v[250:251], v[250:251], v[206:207]
    v_pk_add_f32 v[232:233], v[232:233], v[208:209]
    v_pk_add_f32 v[234:235], v[234:235], v[212:213]
    v_pk_add_f32 v[248:249], v[248:249], v[216:217]
    v_pk_add_f32 v[250:251], v[250:251], v[220:221]
    v_pk_add_f32 v[232:233], v[232:233], v[210:211]
    v_pk_add_f32 v[234:235], v[234:235], v[214:215]
    v_pk_add_f32 v[248:249], v[248:249], v[218:219]
    v_pk_add_f32 v[250:251], v[250:251], v[222:223]
    v_add_f32 v232, v232, v233
    v_add_f32 v234, v234, v235
    v_add_f32 v248, v248, v249
    v_add_f32 v250, v250, v251
    s_nop 1
    v_permlane16_swap_b32 v232, v234
    v_permlane16_swap_b32 v248, v250
    s_nop 0
    v_add_f32 v232, v232, v234
    v_add_f32 v248, v248, v250
    s_nop 1
    v_permlane32_swap_b32 v232, v248
    s_nop 1
    v_add_f32 v232, v232, v248
    v_rcp_f32 v232, v232
    s_nop 0
    v_mov_b32 v248, v232
    s_nop 1
    v_permlane32_swap_b32 v232, v248
    s_nop 1
    v_mov_b32 v234, v232
    v_mov_b32 v250, v248
    s_nop 1
    v_permlane16_swap_b32 v232, v234
    v_permlane16_swap_b32 v248, v250
    s_nop 1
    v_pk_mul_f32 v[32:33], v[32:33], v[232:233] op_sel_hi:[1,0]
    v_pk_mul_f32 v[36:37], v[36:37], v[234:235] op_sel_hi:[1,0]
    v_pk_mul_f32 v[40:41], v[40:41], v[248:249] op_sel_hi:[1,0]
    v_pk_mul_f32 v[44:45], v[44:45], v[250:251] op_sel_hi:[1,0]
    v_pk_mul_f32 v[34:35], v[34:35], v[232:233] op_sel_hi:[1,0]
    v_pk_mul_f32 v[38:39], v[38:39], v[234:235] op_sel_hi:[1,0]
    v_pk_mul_f32 v[42:43], v[42:43], v[248:249] op_sel_hi:[1,0]
    v_pk_mul_f32 v[46:47], v[46:47], v[250:251] op_sel_hi:[1,0]
    v_pk_mul_f32 v[48:49], v[48:49], v[232:233] op_sel_hi:[1,0]
    v_pk_mul_f32 v[52:53], v[52:53], v[234:235] op_sel_hi:[1,0]
    v_pk_mul_f32 v[56:57], v[56:57], v[248:249] op_sel_hi:[1,0]
    v_pk_mul_f32 v[60:61], v[60:61], v[250:251] op_sel_hi:[1,0]
    v_pk_mul_f32 v[50:51], v[50:51], v[232:233] op_sel_hi:[1,0]
    v_pk_mul_f32 v[54:55], v[54:55], v[234:235] op_sel_hi:[1,0]
    v_pk_mul_f32 v[58:59], v[58:59], v[248:249] op_sel_hi:[1,0]
    v_pk_mul_f32 v[62:63], v[62:63], v[250:251] op_sel_hi:[1,0]
    v_pk_mul_f32 v[192:193], v[192:193], v[232:233] op_sel_hi:[1,0]
    v_pk_mul_f32 v[196:197], v[196:197], v[234:235] op_sel_hi:[1,0]
    v_pk_mul_f32 v[200:201], v[200:201], v[248:249] op_sel_hi:[1,0]
    v_pk_mul_f32 v[204:205], v[204:205], v[250:251] op_sel_hi:[1,0]
    v_pk_mul_f32 v[194:195], v[194:195], v[232:233] op_sel_hi:[1,0]
    v_pk_mul_f32 v[198:199], v[198:199], v[234:235] op_sel_hi:[1,0]
    v_pk_mul_f32 v[202:203], v[202:203], v[248:249] op_sel_hi:[1,0]
    v_pk_mul_f32 v[206:207], v[206:207], v[250:251] op_sel_hi:[1,0]
    v_pk_mul_f32 v[208:209], v[208:209], v[232:233] op_sel_hi:[1,0]
    v_pk_mul_f32 v[212:213], v[212:213], v[234:235] op_sel_hi:[1,0]
    v_pk_mul_f32 v[216:217], v[216:217], v[248:249] op_sel_hi:[1,0]
    v_pk_mul_f32 v[220:221], v[220:221], v[250:251] op_sel_hi:[1,0]
    v_pk_mul_f32 v[210:211], v[210:211], v[232:233] op_sel_hi:[1,0]
    v_pk_mul_f32 v[214:215], v[214:215], v[234:235] op_sel_hi:[1,0]
    v_pk_mul_f32 v[218:219], v[218:219], v[248:249] op_sel_hi:[1,0]
    v_pk_mul_f32 v[222:223], v[222:223], v[250:251] op_sel_hi:[1,0]
    v_cvt_pk_bf16_f32 v96, v32, v33
    v_cvt_pk_bf16_f32 v97, v34, v35
    v_cvt_pk_bf16_f32 v98, v48, v49
    v_cvt_pk_bf16_f32 v99, v50, v51
    v_cvt_pk_bf16_f32 v100, v36, v37
    v_cvt_pk_bf16_f32 v101, v38, v39
    v_cvt_pk_bf16_f32 v102, v52, v53
    v_cvt_pk_bf16_f32 v103, v54, v55
    v_cvt_pk_bf16_f32 v104, v40, v41
    v_cvt_pk_bf16_f32 v105, v42, v43
    v_cvt_pk_bf16_f32 v106, v56, v57
    v_cvt_pk_bf16_f32 v107, v58, v59
    v_cvt_pk_bf16_f32 v108, v44, v45
    v_cvt_pk_bf16_f32 v109, v46, v47
    v_cvt_pk_bf16_f32 v110, v60, v61
    v_cvt_pk_bf16_f32 v111, v62, v63
    v_cvt_pk_bf16_f32 v112, v192, v193
    v_cvt_pk_bf16_f32 v113, v194, v195
    v_cvt_pk_bf16_f32 v114, v208, v209
    v_cvt_pk_bf16_f32 v115, v210, v211
    v_cvt_pk_bf16_f32 v116, v196, v197
    v_cvt_pk_bf16_f32 v117, v198, v199
    v_cvt_pk_bf16_f32 v118, v212, v213
    v_cvt_pk_bf16_f32 v119, v214, v215
    v_cvt_pk_bf16_f32 v120, v200, v201
    v_cvt_pk_bf16_f32 v121, v202, v203
    v_cvt_pk_bf16_f32 v122, v216, v217
    v_cvt_pk_bf16_f32 v123, v218, v219
    v_cvt_pk_bf16_f32 v124, v204, v205
    v_cvt_pk_bf16_f32 v125, v206, v207
    v_cvt_pk_bf16_f32 v126, v220, v221
    v_cvt_pk_bf16_f32 v127, v222, v223
    s_barrier
    ds_read_b64_tr_b16 v[128:129], v224 offset:0
    ds_read_b64_tr_b16 v[130:131], v224 offset:4096
    ds_read_b64_tr_b16 v[136:137], v224 offset:8192
    ds_read_b64_tr_b16 v[138:139], v224 offset:12288
    ds_read_b64_tr_b16 v[132:133], v225 offset:0
    ds_read_b64_tr_b16 v[134:135], v225 offset:4096
    ds_read_b64_tr_b16 v[140:141], v225 offset:8192
    ds_read_b64_tr_b16 v[142:143], v225 offset:12288
    ds_read_b64_tr_b16 v[144:145], v226 offset:0
    ds_read_b64_tr_b16 v[146:147], v226 offset:4096
    ds_read_b64_tr_b16 v[152:153], v226 offset:8192
    ds_read_b64_tr_b16 v[154:155], v226 offset:12288
    ds_read_b64_tr_b16 v[148:149], v227 offset:0
    ds_read_b64_tr_b16 v[150:151], v227 offset:4096
    ds_read_b64_tr_b16 v[156:157], v227 offset:8192
    ds_read_b64_tr_b16 v[158:159], v227 offset:12288
    s_waitcnt lgkmcnt(8)
    v_mfma_f32_16x16x32_bf16 v[0:3], v[128:131], v[96:99], 0
    ds_read_b64_tr_b16 v[160:161], v228 offset:0
    s_lshr_b32 s53, s3, 1
    v_mfma_f32_16x16x32_bf16 v[4:7], v[128:131], v[100:103], 0
    ds_read_b64_tr_b16 v[162:163], v228 offset:4096
    s_and_b32 s55, s3, 1
    v_mfma_f32_16x16x32_bf16 v[8:11], v[128:131], v[104:107], 0
    ds_read_b64_tr_b16 v[168:169], v228 offset:8192
    v_add_u32 v242, s52, v236
    v_mfma_f32_16x16x32_bf16 v[12:15], v[128:131], v[108:111], 0
    ds_read_b64_tr_b16 v[170:171], v228 offset:12288
    s_lshl_b32 s55, s55, 11
    v_mfma_f32_16x16x32_bf16 v[28:31], v[132:135], v[108:111], 0
    ds_read_b64_tr_b16 v[164:165], v229 offset:0
    v_add_u32 v244, s55, v236
    v_mfma_f32_16x16x32_bf16 v[24:27], v[132:135], v[104:107], 0
    ds_read_b64_tr_b16 v[166:167], v229 offset:4096
    v_add_u32 v243, 131072, v244
    v_mfma_f32_16x16x32_bf16 v[20:23], v[132:135], v[100:103], 0
    ds_read_b64_tr_b16 v[172:173], v229 offset:8192
    s_lshl_b32 s55, s3, 11
    v_mfma_f32_16x16x32_bf16 v[16:19], v[132:135], v[96:99], 0
    ds_read_b64_tr_b16 v[174:175], v229 offset:12288
    v_add_u32 v245, s55, v236
    v_mfma_f32_16x16x32_bf16 v[0:3], v[136:139], v[112:115], v[0:3]
    s_lshl_b32 s53, s53, 1
    v_lshl_add_u32 v239, v237, 7, v238
    v_mfma_f32_16x16x32_bf16 v[4:7], v[136:139], v[116:119], v[4:7]
    v_bfe_u32 v240, v237, 1, 2
    v_xor_b32 v240, s53, v240
    v_mfma_f32_16x16x32_bf16 v[8:11], v[136:139], v[120:123], v[8:11]
    v_lshl_add_u32 v246, v240, 5, v239
    v_xor_b32 v240, 1, v240
    v_mfma_f32_16x16x32_bf16 v[12:15], v[136:139], v[124:127], v[12:15]
    v_lshl_add_u32 v247, v240, 5, v239
    v_add_u32 v248, 32768, v246
    v_mfma_f32_16x16x32_bf16 v[28:31], v[140:143], v[124:127], v[28:31]
    v_add_u32 v249, 32768, v247
    s_lshl_b32 s55, s50, 12
    v_mfma_f32_16x16x32_bf16 v[24:27], v[140:143], v[120:123], v[24:27]
    s_add_u32 s55, s55, 25165824
    s_add_u32 s16, s28, s55
    v_mfma_f32_16x16x32_bf16 v[20:23], v[140:143], v[116:119], v[20:23]
    s_addc_u32 s17, s29, 0
    s_mov_b32 s18, 0
    v_mfma_f32_16x16x32_bf16 v[16:19], v[140:143], v[112:115], v[16:19]
    s_mov_b32 s19, 0x20000
    s_lshl_b32 s55, s3, 5
    s_waitcnt lgkmcnt(8)
    v_mfma_f32_16x16x32_bf16 v[32:35], v[144:147], v[96:99], 0
    ds_read_b64_tr_b16 v[176:177], v230 offset:0
    ds_read_b64_tr_b16 v[178:179], v230 offset:4096
    v_mfma_f32_16x16x32_bf16 v[36:39], v[144:147], v[100:103], 0
    ds_read_b64_tr_b16 v[184:185], v230 offset:8192
    ds_read_b64_tr_b16 v[186:187], v230 offset:12288
    v_mfma_f32_16x16x32_bf16 v[40:43], v[144:147], v[104:107], 0
    ds_read_b64_tr_b16 v[180:181], v231 offset:0
    ds_read_b64_tr_b16 v[182:183], v231 offset:4096
    v_mfma_f32_16x16x32_bf16 v[44:47], v[144:147], v[108:111], 0
    ds_read_b64_tr_b16 v[188:189], v231 offset:8192
    ds_read_b64_tr_b16 v[190:191], v231 offset:12288
    v_mfma_f32_16x16x32_bf16 v[60:63], v[148:151], v[108:111], 0
    s_lshl_b32 s53, s48, 2
    s_add_u32 s55, s55, s53
    v_mfma_f32_16x16x32_bf16 v[56:59], v[148:151], v[104:107], 0
    v_cvt_pk_bf16_f32 v128, v0, v1
    v_cvt_pk_bf16_f32 v129, v2, v3
    v_mfma_f32_16x16x32_bf16 v[52:55], v[148:151], v[100:103], 0
    v_cvt_pk_bf16_f32 v130, v16, v17
    v_cvt_pk_bf16_f32 v131, v18, v19
    v_mfma_f32_16x16x32_bf16 v[48:51], v[148:151], v[96:99], 0
    ds_write_b128 v242, v[128:131] offset:0
    v_cvt_pk_bf16_f32 v132, v4, v5
    v_mfma_f32_16x16x32_bf16 v[32:35], v[152:155], v[112:115], v[32:35]
    v_cvt_pk_bf16_f32 v133, v6, v7
    v_cvt_pk_bf16_f32 v134, v20, v21
    v_mfma_f32_16x16x32_bf16 v[36:39], v[152:155], v[116:119], v[36:39]
    v_cvt_pk_bf16_f32 v135, v22, v23
    ds_write_b128 v242, v[132:135] offset:1024
    v_mfma_f32_16x16x32_bf16 v[40:43], v[152:155], v[120:123], v[40:43]
    v_cvt_pk_bf16_f32 v136, v8, v9
    v_cvt_pk_bf16_f32 v137, v10, v11
    v_mfma_f32_16x16x32_bf16 v[44:47], v[152:155], v[124:127], v[44:47]
    v_cvt_pk_bf16_f32 v138, v24, v25
    v_cvt_pk_bf16_f32 v139, v26, v27
    v_mfma_f32_16x16x32_bf16 v[60:63], v[156:159], v[124:127], v[60:63]
    ds_write_b128 v242, v[136:139] offset:2048
    v_cvt_pk_bf16_f32 v140, v12, v13
    v_mfma_f32_16x16x32_bf16 v[56:59], v[156:159], v[120:123], v[56:59]
    v_cvt_pk_bf16_f32 v141, v14, v15
    v_cvt_pk_bf16_f32 v142, v28, v29
    v_mfma_f32_16x16x32_bf16 v[52:55], v[156:159], v[116:119], v[52:55]
    v_cvt_pk_bf16_f32 v143, v30, v31
    ds_write_b128 v242, v[140:143] offset:3072
    v_mfma_f32_16x16x32_bf16 v[48:51], v[156:159], v[112:115], v[48:51]
    s_waitcnt lgkmcnt(12)
    v_mfma_f32_16x16x32_bf16 v[64:67], v[160:163], v[96:99], 0
    v_lshl_add_u32 v252, v236, 8, s55
    v_mov_b32 v253, 1
    v_mfma_f32_16x16x32_bf16 v[68:71], v[160:163], v[100:103], 0
    v_mfma_f32_16x16x32_bf16 v[72:75], v[160:163], v[104:107], 0
    v_mfma_f32_16x16x32_bf16 v[76:79], v[160:163], v[108:111], 0
    v_mfma_f32_16x16x32_bf16 v[92:95], v[164:167], v[108:111], 0
    v_cvt_pk_bf16_f32 v144, v32, v33
    v_cvt_pk_bf16_f32 v145, v34, v35
    v_mfma_f32_16x16x32_bf16 v[88:91], v[164:167], v[104:107], 0
    v_cvt_pk_bf16_f32 v146, v48, v49
    v_cvt_pk_bf16_f32 v147, v50, v51
    v_mfma_f32_16x16x32_bf16 v[84:87], v[164:167], v[100:103], 0
    ds_write_b128 v242, v[144:147] offset:4096
    v_cvt_pk_bf16_f32 v148, v36, v37
    v_mfma_f32_16x16x32_bf16 v[80:83], v[164:167], v[96:99], 0
    v_cvt_pk_bf16_f32 v149, v38, v39
    v_cvt_pk_bf16_f32 v150, v52, v53
    v_mfma_f32_16x16x32_bf16 v[64:67], v[168:171], v[112:115], v[64:67]
    v_cvt_pk_bf16_f32 v151, v54, v55
    ds_write_b128 v242, v[148:151] offset:5120
    v_mfma_f32_16x16x32_bf16 v[68:71], v[168:171], v[116:119], v[68:71]
    v_cvt_pk_bf16_f32 v152, v40, v41
    v_cvt_pk_bf16_f32 v153, v42, v43
    v_mfma_f32_16x16x32_bf16 v[72:75], v[168:171], v[120:123], v[72:75]
    v_cvt_pk_bf16_f32 v154, v56, v57
    v_cvt_pk_bf16_f32 v155, v58, v59
    v_mfma_f32_16x16x32_bf16 v[76:79], v[168:171], v[124:127], v[76:79]
    ds_write_b128 v242, v[152:155] offset:6144
    v_cvt_pk_bf16_f32 v156, v44, v45
    v_mfma_f32_16x16x32_bf16 v[92:95], v[172:175], v[124:127], v[92:95]
    v_cvt_pk_bf16_f32 v157, v46, v47
    v_cvt_pk_bf16_f32 v158, v60, v61
    v_mfma_f32_16x16x32_bf16 v[88:91], v[172:175], v[120:123], v[88:91]
    v_cvt_pk_bf16_f32 v159, v62, v63
    ds_write_b128 v242, v[156:159] offset:7168
    v_mfma_f32_16x16x32_bf16 v[84:87], v[172:175], v[116:119], v[84:87]
    v_mfma_f32_16x16x32_bf16 v[80:83], v[172:175], v[112:115], v[80:83]
    s_waitcnt lgkmcnt(8)
    v_mfma_f32_16x16x32_bf16 v[192:195], v[176:179], v[96:99], 0
    v_mfma_f32_16x16x32_bf16 v[196:199], v[176:179], v[100:103], 0
    v_mfma_f32_16x16x32_bf16 v[200:203], v[176:179], v[104:107], 0
    v_mfma_f32_16x16x32_bf16 v[204:207], v[176:179], v[108:111], 0
    v_mfma_f32_16x16x32_bf16 v[220:223], v[180:183], v[108:111], 0
    v_cvt_pk_bf16_f32 v160, v64, v65
    v_cvt_pk_bf16_f32 v161, v66, v67
    v_mfma_f32_16x16x32_bf16 v[216:219], v[180:183], v[104:107], 0
    v_cvt_pk_bf16_f32 v162, v80, v81
    v_cvt_pk_bf16_f32 v163, v82, v83
    v_mfma_f32_16x16x32_bf16 v[212:215], v[180:183], v[100:103], 0
    ds_write_b128 v242, v[160:163] offset:8192
    v_cvt_pk_bf16_f32 v164, v68, v69
    v_mfma_f32_16x16x32_bf16 v[208:211], v[180:183], v[96:99], 0
    v_cvt_pk_bf16_f32 v165, v70, v71
    v_cvt_pk_bf16_f32 v166, v84, v85
    v_mfma_f32_16x16x32_bf16 v[192:195], v[184:187], v[112:115], v[192:195]
    v_cvt_pk_bf16_f32 v167, v86, v87
    ds_write_b128 v242, v[164:167] offset:9216
    v_mfma_f32_16x16x32_bf16 v[196:199], v[184:187], v[116:119], v[196:199]
    v_cvt_pk_bf16_f32 v168, v72, v73
    v_cvt_pk_bf16_f32 v169, v74, v75
    v_mfma_f32_16x16x32_bf16 v[200:203], v[184:187], v[120:123], v[200:203]
    v_cvt_pk_bf16_f32 v170, v88, v89
    v_cvt_pk_bf16_f32 v171, v90, v91
    v_mfma_f32_16x16x32_bf16 v[204:207], v[184:187], v[124:127], v[204:207]
    ds_write_b128 v242, v[168:171] offset:10240
    v_cvt_pk_bf16_f32 v172, v76, v77
    v_mfma_f32_16x16x32_bf16 v[220:223], v[188:191], v[124:127], v[220:223]
    v_cvt_pk_bf16_f32 v173, v78, v79
    v_cvt_pk_bf16_f32 v174, v92, v93
    v_mfma_f32_16x16x32_bf16 v[216:219], v[188:191], v[120:123], v[216:219]
    v_cvt_pk_bf16_f32 v175, v94, v95
    ds_write_b128 v242, v[172:175] offset:11264
    v_mfma_f32_16x16x32_bf16 v[212:215], v[188:191], v[116:119], v[212:215]
    v_mfma_f32_16x16x32_bf16 v[208:211], v[188:191], v[112:115], v[208:211]
    s_nop 6
    v_cvt_pk_bf16_f32 v176, v192, v193
    v_cvt_pk_bf16_f32 v177, v194, v195
    v_cvt_pk_bf16_f32 v178, v208, v209
    v_cvt_pk_bf16_f32 v179, v210, v211
    ds_write_b128 v242, v[176:179] offset:12288
    v_cvt_pk_bf16_f32 v180, v196, v197
    v_cvt_pk_bf16_f32 v181, v198, v199
    v_cvt_pk_bf16_f32 v182, v212, v213
    v_cvt_pk_bf16_f32 v183, v214, v215
    ds_write_b128 v242, v[180:183] offset:13312
    v_cvt_pk_bf16_f32 v184, v200, v201
    v_cvt_pk_bf16_f32 v185, v202, v203
    v_cvt_pk_bf16_f32 v186, v216, v217
    v_cvt_pk_bf16_f32 v187, v218, v219
    ds_write_b128 v242, v[184:187] offset:14336
    v_cvt_pk_bf16_f32 v188, v204, v205
    v_cvt_pk_bf16_f32 v189, v206, v207
    v_cvt_pk_bf16_f32 v190, v220, v221
    v_cvt_pk_bf16_f32 v191, v222, v223
    ds_write_b128 v242, v[188:191] offset:15360
    s_waitcnt lgkmcnt(0)
    s_barrier
    ds_read_b128 v[0:3], v243 offset:0
    ds_read_b128 v[4:7], v243 offset:1024
    ds_read_b128 v[8:11], v243 offset:4096
    ds_read_b128 v[12:15], v243 offset:5120
    ds_read_b128 v[16:19], v243 offset:8192
    ds_read_b128 v[20:23], v243 offset:9216
    ds_read_b128 v[24:27], v243 offset:12288
    ds_read_b128 v[28:31], v243 offset:13312
    ds_read_b128 v[32:35], v243 offset:16384
    ds_read_b128 v[36:39], v243 offset:17408
    ds_read_b128 v[40:43], v243 offset:20480
    ds_read_b128 v[44:47], v243 offset:21504
    ds_read_b128 v[48:51], v243 offset:24576
    ds_read_b128 v[52:55], v243 offset:25600
    ds_read_b128 v[56:59], v243 offset:28672
    ds_read_b128 v[60:63], v243 offset:29696
    ds_read_b64_tr_b16 v[160:161], v248 offset:0
    ds_read_b64_tr_b16 v[162:163], v248 offset:2048
    ds_read_b64_tr_b16 v[164:165], v249 offset:0
    ds_read_b64_tr_b16 v[166:167], v249 offset:2048
    ds_read_b64_tr_b16 v[168:169], v248 offset:4096
    ds_read_b64_tr_b16 v[170:171], v248 offset:6144
    ds_read_b64_tr_b16 v[172:173], v249 offset:4096
    ds_read_b64_tr_b16 v[174:175], v249 offset:6144
    ds_read_b64_tr_b16 v[176:177], v248 offset:8192
    ds_read_b64_tr_b16 v[178:179], v248 offset:10240
    ds_read_b64_tr_b16 v[180:181], v249 offset:8192
    ds_read_b64_tr_b16 v[182:183], v249 offset:10240
    ds_read_b64_tr_b16 v[184:185], v248 offset:12288
    ds_read_b64_tr_b16 v[186:187], v248 offset:14336
    ds_read_b64_tr_b16 v[188:189], v249 offset:12288
    s_mov_b32 s54, 0
    s_mov_b32 s55, 49152
    v_add_u32 v248, s55, v246
    s_mov_b32 s58, 65536
    s_mov_b32 s59, s48
    s_mov_b32 s60, 0
    s_waitcnt lgkmcnt(0)
    s_barrier
    v_mfma_f32_16x16x32_bf16 v[128:131], v[160:163], v[0:3], 0
    ds_read_b64_tr_b16 v[190:191], v249 offset:14336
    v_add_u32 v249, s55, v247
    v_mfma_f32_16x16x32_bf16 v[136:139], v[160:163], v[4:7], 0
    ds_read_b64_tr_b16 v[160:161], v248 offset:0
    ds_read_b128 v[64:67], v244 offset:0
    ds_read_b128 v[96:99], v244 offset:16384
    v_mfma_f32_16x16x32_bf16 v[140:143], v[164:167], v[4:7], 0
    ds_read_b64_tr_b16 v[162:163], v248 offset:2048
    ds_read_b128 v[68:71], v244 offset:1024
    ds_read_b128 v[100:103], v244 offset:17408
    v_mfma_f32_16x16x32_bf16 v[132:135], v[164:167], v[0:3], 0
    ds_read_b64_tr_b16 v[164:165], v249 offset:0
    s_waitcnt lgkmcnt(11)
    v_mfma_f32_16x16x32_bf16 v[128:131], v[168:171], v[8:11], v[128:131]
    ds_read_b64_tr_b16 v[166:167], v249 offset:2048
    ds_read_b128 v[72:75], v244 offset:4096
    ds_read_b128 v[104:107], v244 offset:20480
    v_mfma_f32_16x16x32_bf16 v[136:139], v[168:171], v[12:15], v[136:139]
    ds_read_b64_tr_b16 v[168:169], v248 offset:4096
    ds_read_b128 v[76:79], v244 offset:5120
    ds_read_b128 v[108:111], v244 offset:21504
    v_mfma_f32_16x16x32_bf16 v[140:143], v[172:175], v[12:15], v[140:143]
    ds_read_b64_tr_b16 v[170:171], v248 offset:6144
    ds_read_b128 v[80:83], v244 offset:8192
    ds_read_b128 v[112:115], v244 offset:24576
    v_mfma_f32_16x16x32_bf16 v[132:135], v[172:175], v[8:11], v[132:135]
    ds_read_b64_tr_b16 v[172:173], v249 offset:4096
    s_waitcnt lgkmcnt(11)
    v_mfma_f32_16x16x32_bf16 v[128:131], v[176:179], v[16:19], v[128:131]
    ds_read_b64_tr_b16 v[174:175], v249 offset:6144
    ds_read_b128 v[84:87], v244 offset:9216
    ds_read_b128 v[116:119], v244 offset:25600
    v_mfma_f32_16x16x32_bf16 v[136:139], v[176:179], v[20:23], v[136:139]
    ds_read_b64_tr_b16 v[176:177], v248 offset:8192
    ds_read_b128 v[88:91], v244 offset:12288
    ds_read_b128 v[120:123], v244 offset:28672
    v_mfma_f32_16x16x32_bf16 v[140:143], v[180:183], v[20:23], v[140:143]
    ds_read_b64_tr_b16 v[178:179], v248 offset:10240
    ds_read_b128 v[92:95], v244 offset:13312
    ds_read_b128 v[124:127], v244 offset:29696
    v_mfma_f32_16x16x32_bf16 v[132:135], v[180:183], v[16:19], v[132:135]
    ds_read_b64_tr_b16 v[180:181], v249 offset:8192
    s_waitcnt lgkmcnt(11)
    v_mfma_f32_16x16x32_bf16 v[128:131], v[184:187], v[24:27], v[128:131]
    ds_read_b64_tr_b16 v[182:183], v249 offset:10240
    s_add_u32 s55, s55, 16384
    s_cmp_eq_u32 s55, 163840
    v_mfma_f32_16x16x32_bf16 v[136:139], v[184:187], v[28:31], v[136:139]
    ds_read_b64_tr_b16 v[184:185], v248 offset:12288
    s_cselect_b32 s55, 0, s55
    v_mfma_f32_16x16x32_bf16 v[140:143], v[188:191], v[28:31], v[140:143]
    ds_read_b64_tr_b16 v[186:187], v248 offset:14336
    v_add_u32 v248, s55, v246
    v_mfma_f32_16x16x32_bf16 v[132:135], v[188:191], v[24:27], v[132:135]
    ds_read_b64_tr_b16 v[188:189], v249 offset:12288
    s_waitcnt lgkmcnt(11)
    v_mfma_f32_16x16x32_bf16 v[128:131], v[160:163], v[32:35], v[128:131]
    ds_read_b64_tr_b16 v[190:191], v249 offset:14336
    v_add_u32 v249, s55, v247
    v_mfma_f32_16x16x32_bf16 v[136:139], v[160:163], v[36:39], v[136:139]
    ds_read_b64_tr_b16 v[160:161], v248 offset:0
    v_mfma_f32_16x16x32_bf16 v[140:143], v[164:167], v[36:39], v[140:143]
    ds_read_b64_tr_b16 v[162:163], v248 offset:2048
    v_mfma_f32_16x16x32_bf16 v[132:135], v[164:167], v[32:35], v[132:135]
    ds_read_b64_tr_b16 v[164:165], v249 offset:0
    s_waitcnt lgkmcnt(11)
    v_mfma_f32_16x16x32_bf16 v[128:131], v[168:171], v[40:43], v[128:131]
    ds_read_b64_tr_b16 v[166:167], v249 offset:2048
    v_mfma_f32_16x16x32_bf16 v[136:139], v[168:171], v[44:47], v[136:139]
    ds_read_b64_tr_b16 v[168:169], v248 offset:4096
    v_mfma_f32_16x16x32_bf16 v[140:143], v[172:175], v[44:47], v[140:143]
    ds_read_b64_tr_b16 v[170:171], v248 offset:6144
    v_mfma_f32_16x16x32_bf16 v[132:135], v[172:175], v[40:43], v[132:135]
    ds_read_b64_tr_b16 v[172:173], v249 offset:4096
    s_waitcnt lgkmcnt(11)
    v_mfma_f32_16x16x32_bf16 v[128:131], v[176:179], v[48:51], v[128:131]
    ds_read_b64_tr_b16 v[174:175], v249 offset:6144
    s_add_u32 s55, s55, 16384
    v_mfma_f32_16x16x32_bf16 v[136:139], v[176:179], v[52:55], v[136:139]
    ds_read_b64_tr_b16 v[176:177], v248 offset:8192
    s_cmp_eq_u32 s55, 163840
    v_mfma_f32_16x16x32_bf16 v[140:143], v[180:183], v[52:55], v[140:143]
    ds_read_b64_tr_b16 v[178:179], v248 offset:10240
    s_cselect_b32 s55, 0, s55
    v_mfma_f32_16x16x32_bf16 v[132:135], v[180:183], v[48:51], v[132:135]
    ds_read_b64_tr_b16 v[180:181], v249 offset:8192
    s_waitcnt lgkmcnt(11)
    v_mfma_f32_16x16x32_bf16 v[128:131], v[184:187], v[56:59], v[128:131]
    ds_read_b64_tr_b16 v[182:183], v249 offset:10240
    v_mfma_f32_16x16x32_bf16 v[136:139], v[184:187], v[60:63], v[136:139]
    ds_read_b64_tr_b16 v[184:185], v248 offset:12288
    v_mfma_f32_16x16x32_bf16 v[140:143], v[188:191], v[60:63], v[140:143]
    ds_read_b64_tr_b16 v[186:187], v248 offset:14336
    v_add_u32 v248, s55, v246
    v_mfma_f32_16x16x32_bf16 v[132:135], v[188:191], v[56:59], v[132:135]
    ds_read_b64_tr_b16 v[188:189], v249 offset:12288
    s_waitcnt lgkmcnt(11)
    s_barrier
    v_mfma_f32_16x16x32_bf16 v[128:131], v[160:163], v[64:67], v[128:131]
    ds_read_b64_tr_b16 v[190:191], v249 offset:14336
    v_add_u32 v249, s55, v247
    v_mfma_f32_16x16x32_bf16 v[136:139], v[160:163], v[68:71], v[136:139]
    ds_read_b64_tr_b16 v[160:161], v248 offset:0
    v_mfma_f32_16x16x32_bf16 v[140:143], v[164:167], v[68:71], v[140:143]
    ds_read_b64_tr_b16 v[162:163], v248 offset:2048
    v_mfma_f32_16x16x32_bf16 v[132:135], v[164:167], v[64:67], v[132:135]
    ds_read_b64_tr_b16 v[164:165], v249 offset:0
    s_waitcnt lgkmcnt(11)
    v_mfma_f32_16x16x32_bf16 v[128:131], v[168:171], v[72:75], v[128:131]
    ds_read_b64_tr_b16 v[166:167], v249 offset:2048
    v_mfma_f32_16x16x32_bf16 v[136:139], v[168:171], v[76:79], v[136:139]
    ds_read_b64_tr_b16 v[168:169], v248 offset:4096
    v_mfma_f32_16x16x32_bf16 v[140:143], v[172:175], v[76:79], v[140:143]
    ds_read_b64_tr_b16 v[170:171], v248 offset:6144
    v_mfma_f32_16x16x32_bf16 v[132:135], v[172:175], v[72:75], v[132:135]
    ds_read_b64_tr_b16 v[172:173], v249 offset:4096
    s_waitcnt lgkmcnt(11)
    v_mfma_f32_16x16x32_bf16 v[128:131], v[176:179], v[80:83], v[128:131]
    ds_read_b64_tr_b16 v[174:175], v249 offset:6144
    s_add_u32 s55, s55, 16384
    v_mfma_f32_16x16x32_bf16 v[136:139], v[176:179], v[84:87], v[136:139]
    ds_read_b64_tr_b16 v[176:177], v248 offset:8192
    s_cmp_eq_u32 s55, 163840
    v_mfma_f32_16x16x32_bf16 v[140:143], v[180:183], v[84:87], v[140:143]
    ds_read_b64_tr_b16 v[178:179], v248 offset:10240
    s_cselect_b32 s55, 0, s55
    v_mfma_f32_16x16x32_bf16 v[132:135], v[180:183], v[80:83], v[132:135]
    ds_read_b64_tr_b16 v[180:181], v249 offset:8192
    s_waitcnt lgkmcnt(11)
    v_mfma_f32_16x16x32_bf16 v[128:131], v[184:187], v[88:91], v[128:131]
    ds_read_b64_tr_b16 v[182:183], v249 offset:10240
    v_mfma_f32_16x16x32_bf16 v[136:139], v[184:187], v[92:95], v[136:139]
    ds_read_b64_tr_b16 v[184:185], v248 offset:12288
    v_mfma_f32_16x16x32_bf16 v[140:143], v[188:191], v[92:95], v[140:143]
    ds_read_b64_tr_b16 v[186:187], v248 offset:14336
    v_add_u32 v248, s55, v246
    v_mfma_f32_16x16x32_bf16 v[132:135], v[188:191], v[88:91], v[132:135]
    ds_read_b64_tr_b16 v[188:189], v249 offset:12288
    s_waitcnt lgkmcnt(11)
    v_mfma_f32_16x16x32_bf16 v[128:131], v[160:163], v[96:99], v[128:131]
    ds_read_b64_tr_b16 v[190:191], v249 offset:14336
    v_add_u32 v249, s55, v247
    v_mfma_f32_16x16x32_bf16 v[136:139], v[160:163], v[100:103], v[136:139]
    ds_read_b64_tr_b16 v[160:161], v248 offset:0
    v_mfma_f32_16x16x32_bf16 v[140:143], v[164:167], v[100:103], v[140:143]
    ds_read_b64_tr_b16 v[162:163], v248 offset:2048
    v_mfma_f32_16x16x32_bf16 v[132:135], v[164:167], v[96:99], v[132:135]
    ds_read_b64_tr_b16 v[164:165], v249 offset:0
    s_waitcnt lgkmcnt(11)
    v_mfma_f32_16x16x32_bf16 v[128:131], v[168:171], v[104:107], v[128:131]
    ds_read_b64_tr_b16 v[166:167], v249 offset:2048
    v_mfma_f32_16x16x32_bf16 v[136:139], v[168:171], v[108:111], v[136:139]
    ds_read_b64_tr_b16 v[168:169], v248 offset:4096
    v_mfma_f32_16x16x32_bf16 v[140:143], v[172:175], v[108:111], v[140:143]
    ds_read_b64_tr_b16 v[170:171], v248 offset:6144
    v_mfma_f32_16x16x32_bf16 v[132:135], v[172:175], v[104:107], v[132:135]
    ds_read_b64_tr_b16 v[172:173], v249 offset:4096
    s_waitcnt lgkmcnt(11)
    v_mfma_f32_16x16x32_bf16 v[128:131], v[176:179], v[112:115], v[128:131]
    ds_read_b64_tr_b16 v[174:175], v249 offset:6144
    s_add_u32 s55, s55, 16384
    v_mfma_f32_16x16x32_bf16 v[136:139], v[176:179], v[116:119], v[136:139]
    ds_read_b64_tr_b16 v[176:177], v248 offset:8192
    s_cmp_eq_u32 s55, 163840
    v_mfma_f32_16x16x32_bf16 v[140:143], v[180:183], v[116:119], v[140:143]
    ds_read_b64_tr_b16 v[178:179], v248 offset:10240
    s_cselect_b32 s55, 0, s55
    v_mfma_f32_16x16x32_bf16 v[132:135], v[180:183], v[112:115], v[132:135]
    ds_read_b64_tr_b16 v[180:181], v249 offset:8192
    s_waitcnt lgkmcnt(11)
    v_mfma_f32_16x16x32_bf16 v[144:147], v[184:187], v[120:123], v[128:131]
    ds_read_b64_tr_b16 v[182:183], v249 offset:10240
    v_mfma_f32_16x16x32_bf16 v[152:155], v[184:187], v[124:127], v[136:139]
    ds_read_b64_tr_b16 v[184:185], v248 offset:12288
    v_mfma_f32_16x16x32_bf16 v[156:159], v[188:191], v[124:127], v[140:143]
    ds_read_b64_tr_b16 v[186:187], v248 offset:14336
    v_add_u32 v248, s55, v246
    v_mfma_f32_16x16x32_bf16 v[148:151], v[188:191], v[120:123], v[132:135]
    ds_read_b64_tr_b16 v[188:189], v249 offset:12288
    s_waitcnt lgkmcnt(11)
L_p2_loop:
    s_barrier
    v_mfma_f32_16x16x32_bf16 v[128:131], v[160:163], v[0:3], 0
    ds_read_b64_tr_b16 v[190:191], v249 offset:14336
    v_add_u32 v249, s55, v247
    v_mfma_f32_16x16x32_bf16 v[136:139], v[160:163], v[4:7], 0
    ds_read_b64_tr_b16 v[160:161], v248 offset:0
    v_cvt_pk_bf16_f32 v192, v144, v145
    v_mfma_f32_16x16x32_bf16 v[140:143], v[164:167], v[4:7], 0
    ds_read_b64_tr_b16 v[162:163], v248 offset:2048
    v_cvt_pk_bf16_f32 v193, v146, v147
    v_mfma_f32_16x16x32_bf16 v[132:135], v[164:167], v[0:3], 0
    ds_read_b64_tr_b16 v[164:165], v249 offset:0
    s_waitcnt lgkmcnt(11)
    v_mfma_f32_16x16x32_bf16 v[128:131], v[168:171], v[8:11], v[128:131]
    ds_read_b64_tr_b16 v[166:167], v249 offset:2048
    v_cvt_pk_bf16_f32 v194, v148, v149
    v_mfma_f32_16x16x32_bf16 v[136:139], v[168:171], v[12:15], v[136:139]
    ds_read_b64_tr_b16 v[168:169], v248 offset:4096
    v_cvt_pk_bf16_f32 v195, v150, v151
    v_mfma_f32_16x16x32_bf16 v[140:143], v[172:175], v[12:15], v[140:143]
    ds_read_b64_tr_b16 v[170:171], v248 offset:6144
    v_cvt_pk_bf16_f32 v196, v152, v153
    v_mfma_f32_16x16x32_bf16 v[132:135], v[172:175], v[8:11], v[132:135]
    ds_read_b64_tr_b16 v[172:173], v249 offset:4096
    s_waitcnt lgkmcnt(11)
    v_mfma_f32_16x16x32_bf16 v[128:131], v[176:179], v[16:19], v[128:131]
    ds_read_b64_tr_b16 v[174:175], v249 offset:6144
    v_cvt_pk_bf16_f32 v197, v154, v155
    v_mfma_f32_16x16x32_bf16 v[136:139], v[176:179], v[20:23], v[136:139]
    ds_read_b64_tr_b16 v[176:177], v248 offset:8192
    v_cvt_pk_bf16_f32 v198, v156, v157
    v_mfma_f32_16x16x32_bf16 v[140:143], v[180:183], v[20:23], v[140:143]
    ds_read_b64_tr_b16 v[178:179], v248 offset:10240
    v_cvt_pk_bf16_f32 v199, v158, v159
    v_mfma_f32_16x16x32_bf16 v[132:135], v[180:183], v[16:19], v[132:135]
    ds_read_b64_tr_b16 v[180:181], v249 offset:8192
    s_waitcnt lgkmcnt(11)
    v_mfma_f32_16x16x32_bf16 v[128:131], v[184:187], v[24:27], v[128:131]
    ds_read_b64_tr_b16 v[182:183], v249 offset:10240
    s_add_u32 s55, s55, 16384
    s_cmp_eq_u32 s55, 163840
    v_mfma_f32_16x16x32_bf16 v[136:139], v[184:187], v[28:31], v[136:139]
    ds_read_b64_tr_b16 v[184:185], v248 offset:12288
    s_cselect_b32 s55, 0, s55
    v_mfma_f32_16x16x32_bf16 v[140:143], v[188:191], v[28:31], v[140:143]
    ds_read_b64_tr_b16 v[186:187], v248 offset:14336
    v_add_u32 v248, s55, v246
    v_mfma_f32_16x16x32_bf16 v[132:135], v[188:191], v[24:27], v[132:135]
    ds_read_b64_tr_b16 v[188:189], v249 offset:12288
    s_waitcnt lgkmcnt(11)
    v_mfma_f32_16x16x32_bf16 v[128:131], v[160:163], v[32:35], v[128:131]
    ds_read_b64_tr_b16 v[190:191], v249 offset:14336
    v_add_u32 v249, s55, v247
    v_mfma_f32_16x16x32_bf16 v[136:139], v[160:163], v[36:39], v[136:139]
    ds_read_b64_tr_b16 v[160:161], v248 offset:0
    buffer_store_dwordx4 v[192:195], v245, s[32:35], s58 offen offset:0 sc1
    v_mfma_f32_16x16x32_bf16 v[140:143], v[164:167], v[36:39], v[140:143]
    ds_read_b64_tr_b16 v[162:163], v248 offset:2048
    buffer_store_dwordx4 v[196:199], v245, s[32:35], s58 offen offset:1024 sc1
    s_waitcnt vmcnt(2)
    buffer_store_dword v253, v252, s[16:19], s60 offen sc1
    v_mfma_f32_16x16x32_bf16 v[132:135], v[164:167], v[32:35], v[132:135]
    ds_read_b64_tr_b16 v[164:165], v249 offset:0
    s_waitcnt lgkmcnt(11)
    v_mfma_f32_16x16x32_bf16 v[128:131], v[168:171], v[40:43], v[128:131]
    ds_read_b64_tr_b16 v[166:167], v249 offset:2048
    v_mfma_f32_16x16x32_bf16 v[136:139], v[168:171], v[44:47], v[136:139]
    ds_read_b64_tr_b16 v[168:169], v248 offset:4096
    v_mfma_f32_16x16x32_bf16 v[140:143], v[172:175], v[44:47], v[140:143]
    ds_read_b64_tr_b16 v[170:171], v248 offset:6144
    v_mfma_f32_16x16x32_bf16 v[132:135], v[172:175], v[40:43], v[132:135]
    ds_read_b64_tr_b16 v[172:173], v249 offset:4096
    s_waitcnt lgkmcnt(11)
    v_mfma_f32_16x16x32_bf16 v[128:131], v[176:179], v[48:51], v[128:131]
    ds_read_b64_tr_b16 v[174:175], v249 offset:6144
    s_add_u32 s55, s55, 16384
    v_mfma_f32_16x16x32_bf16 v[136:139], v[176:179], v[52:55], v[136:139]
    ds_read_b64_tr_b16 v[176:177], v248 offset:8192
    s_cmp_eq_u32 s55, 163840
    v_mfma_f32_16x16x32_bf16 v[140:143], v[180:183], v[52:55], v[140:143]
    ds_read_b64_tr_b16 v[178:179], v248 offset:10240
    s_cselect_b32 s55, 0, s55
    v_mfma_f32_16x16x32_bf16 v[132:135], v[180:183], v[48:51], v[132:135]
    ds_read_b64_tr_b16 v[180:181], v249 offset:8192
    s_waitcnt lgkmcnt(11)
    v_mfma_f32_16x16x32_bf16 v[128:131], v[184:187], v[56:59], v[128:131]
    ds_read_b64_tr_b16 v[182:183], v249 offset:10240
    v_mfma_f32_16x16x32_bf16 v[136:139], v[184:187], v[60:63], v[136:139]
    ds_read_b64_tr_b16 v[184:185], v248 offset:12288
    v_mfma_f32_16x16x32_bf16 v[140:143], v[188:191], v[60:63], v[140:143]
    ds_read_b64_tr_b16 v[186:187], v248 offset:14336
    v_add_u32 v248, s55, v246
    v_mfma_f32_16x16x32_bf16 v[132:135], v[188:191], v[56:59], v[132:135]
    ds_read_b64_tr_b16 v[188:189], v249 offset:12288
    s_waitcnt lgkmcnt(11)
    s_barrier
    v_mfma_f32_16x16x32_bf16 v[128:131], v[160:163], v[64:67], v[128:131]
    ds_read_b64_tr_b16 v[190:191], v249 offset:14336
    v_add_u32 v249, s55, v247
    v_mfma_f32_16x16x32_bf16 v[136:139], v[160:163], v[68:71], v[136:139]
    ds_read_b64_tr_b16 v[160:161], v248 offset:0
    v_mfma_f32_16x16x32_bf16 v[140:143], v[164:167], v[68:71], v[140:143]
    ds_read_b64_tr_b16 v[162:163], v248 offset:2048
    v_mfma_f32_16x16x32_bf16 v[132:135], v[164:167], v[64:67], v[132:135]
    ds_read_b64_tr_b16 v[164:165], v249 offset:0
    s_waitcnt lgkmcnt(11)
    v_mfma_f32_16x16x32_bf16 v[128:131], v[168:171], v[72:75], v[128:131]
    ds_read_b64_tr_b16 v[166:167], v249 offset:2048
    v_mfma_f32_16x16x32_bf16 v[136:139], v[168:171], v[76:79], v[136:139]
    ds_read_b64_tr_b16 v[168:169], v248 offset:4096
    v_mfma_f32_16x16x32_bf16 v[140:143], v[172:175], v[76:79], v[140:143]
    ds_read_b64_tr_b16 v[170:171], v248 offset:6144
    v_mfma_f32_16x16x32_bf16 v[132:135], v[172:175], v[72:75], v[132:135]
    ds_read_b64_tr_b16 v[172:173], v249 offset:4096
    s_waitcnt lgkmcnt(11)
    v_mfma_f32_16x16x32_bf16 v[128:131], v[176:179], v[80:83], v[128:131]
    ds_read_b64_tr_b16 v[174:175], v249 offset:6144
    s_add_u32 s55, s55, 16384
    v_mfma_f32_16x16x32_bf16 v[136:139], v[176:179], v[84:87], v[136:139]
    ds_read_b64_tr_b16 v[176:177], v248 offset:8192
    s_cmp_eq_u32 s55, 163840
    v_mfma_f32_16x16x32_bf16 v[140:143], v[180:183], v[84:87], v[140:143]
    ds_read_b64_tr_b16 v[178:179], v248 offset:10240
    s_cselect_b32 s55, 0, s55
    v_mfma_f32_16x16x32_bf16 v[132:135], v[180:183], v[80:83], v[132:135]
    ds_read_b64_tr_b16 v[180:181], v249 offset:8192
    s_waitcnt lgkmcnt(11)
    v_mfma_f32_16x16x32_bf16 v[128:131], v[184:187], v[88:91], v[128:131]
    ds_read_b64_tr_b16 v[182:183], v249 offset:10240
    v_mfma_f32_16x16x32_bf16 v[136:139], v[184:187], v[92:95], v[136:139]
    ds_read_b64_tr_b16 v[184:185], v248 offset:12288
    v_mfma_f32_16x16x32_bf16 v[140:143], v[188:191], v[92:95], v[140:143]
    ds_read_b64_tr_b16 v[186:187], v248 offset:14336
    v_add_u32 v248, s55, v246
    v_mfma_f32_16x16x32_bf16 v[132:135], v[188:191], v[88:91], v[132:135]
    ds_read_b64_tr_b16 v[188:189], v249 offset:12288
    s_waitcnt lgkmcnt(11)
    v_mfma_f32_16x16x32_bf16 v[128:131], v[160:163], v[96:99], v[128:131]
    ds_read_b64_tr_b16 v[190:191], v249 offset:14336
    v_add_u32 v249, s55, v247
    v_mfma_f32_16x16x32_bf16 v[136:139], v[160:163], v[100:103], v[136:139]
    ds_read_b64_tr_b16 v[160:161], v248 offset:0
    s_lshr_b32 s60, s58, 6
    v_mfma_f32_16x16x32_bf16 v[140:143], v[164:167], v[100:103], v[140:143]
    ds_read_b64_tr_b16 v[162:163], v248 offset:2048
    s_add_u32 s59, s59, 1
    v_mfma_f32_16x16x32_bf16 v[132:135], v[164:167], v[96:99], v[132:135]
    ds_read_b64_tr_b16 v[164:165], v249 offset:0
    s_waitcnt lgkmcnt(11)
    v_mfma_f32_16x16x32_bf16 v[128:131], v[168:171], v[104:107], v[128:131]
    ds_read_b64_tr_b16 v[166:167], v249 offset:2048
    s_and_b32 s59, s59, 7
    v_mfma_f32_16x16x32_bf16 v[136:139], v[168:171], v[108:111], v[136:139]
    ds_read_b64_tr_b16 v[168:169], v248 offset:4096
    s_lshl_b32 s58, s59, 13
    v_mfma_f32_16x16x32_bf16 v[140:143], v[172:175], v[108:111], v[140:143]
    ds_read_b64_tr_b16 v[170:171], v248 offset:6144
    s_mov_b32 s18, 4096
    v_mfma_f32_16x16x32_bf16 v[132:135], v[172:175], v[104:107], v[132:135]
    ds_read_b64_tr_b16 v[172:173], v249 offset:4096
    s_waitcnt lgkmcnt(11)
    v_mfma_f32_16x16x32_bf16 v[128:131], v[176:179], v[112:115], v[128:131]
    ds_read_b64_tr_b16 v[174:175], v249 offset:6144
    s_add_u32 s55, s55, 16384
    v_mfma_f32_16x16x32_bf16 v[136:139], v[176:179], v[116:119], v[136:139]
    ds_read_b64_tr_b16 v[176:177], v248 offset:8192
    s_cmp_eq_u32 s55, 163840
    v_mfma_f32_16x16x32_bf16 v[140:143], v[180:183], v[116:119], v[140:143]
    ds_read_b64_tr_b16 v[178:179], v248 offset:10240
    s_cselect_b32 s55, 0, s55
    v_mfma_f32_16x16x32_bf16 v[132:135], v[180:183], v[112:115], v[132:135]
    ds_read_b64_tr_b16 v[180:181], v249 offset:8192
    s_waitcnt lgkmcnt(11)
    v_mfma_f32_16x16x32_bf16 v[144:147], v[184:187], v[120:123], v[128:131]
    ds_read_b64_tr_b16 v[182:183], v249 offset:10240
    v_mfma_f32_16x16x32_bf16 v[152:155], v[184:187], v[124:127], v[136:139]
    ds_read_b64_tr_b16 v[184:185], v248 offset:12288
    s_add_u32 s54, s54, 1
    v_mfma_f32_16x16x32_bf16 v[156:159], v[188:191], v[124:127], v[140:143]
    ds_read_b64_tr_b16 v[186:187], v248 offset:14336
    v_add_u32 v248, s55, v246
    v_mfma_f32_16x16x32_bf16 v[148:151], v[188:191], v[120:123], v[132:135]
    ds_read_b64_tr_b16 v[188:189], v249 offset:12288
    s_waitcnt lgkmcnt(11)
    s_cmp_lg_u32 s54, 8
    s_cbranch_scc1 L_p2_loop
    s_waitcnt vmcnt(1)
    buffer_store_dword v253, v252, s[16:19], s60 offen sc1
    s_lshr_b32 s52, s48, 1
    s_lshl_b32 s52, s52, 5
    s_add_u32 s52, s52, 1024
    s_nop 1
    v_cvt_pk_bf16_f32 v192, v144, v145
    v_cvt_pk_bf16_f32 v193, v146, v147
    v_cvt_pk_bf16_f32 v194, v148, v149
    v_cvt_pk_bf16_f32 v195, v150, v151
    ds_write_b128 v245, v[192:195] offset:0
    v_cvt_pk_bf16_f32 v196, v152, v153
    v_cvt_pk_bf16_f32 v197, v154, v155
    v_cvt_pk_bf16_f32 v198, v156, v157
    v_cvt_pk_bf16_f32 v199, v158, v159
    ds_write_b128 v245, v[196:199] offset:1024
    s_cmp_eq_u32 s3, 0
    s_cbranch_scc1 L_last
    s_waitcnt lgkmcnt(0)
    s_barrier
    s_endpgm
L_last:
    s_waitcnt lgkmcnt(0)
    s_load_dwordx8 s[72:79], s[16:17], s52 glc
    s_barrier
    s_mov_b32 s47, s52
    v_lshrrev_b32 v30, 4, v236
    s_mul_i32 s52, s50, 589824
    s_add_u32 s36, s28, s52
    s_addc_u32 s37, s29, 0
    s_mov_b32 s38, 589824
    s_mov_b32 s39, 0x20000
    s_mov_b32 s40, s24
    s_mov_b32 s41, s25
    s_mov_b32 s42, 2359296
    s_mov_b32 s43, 0x20000
    s_lshl_b32 s52, s48, 10
    v_lshl_add_u32 v22, v30, 4, s52
    v_lshrrev_b32 v26, 2, v30
    v_and_b32 v27, 3, v30
    v_mul_u32_u24 v23, 2304, v26
    v_lshl_add_u32 v23, v27, 3, v23
    v_lshl_add_u32 v21, v27, 4, v26
    v_lshlrev_b32 v21, 2, v21
    s_and_b32 s52, s48, 3
    s_lshl_b32 s52, s52, 4
    s_lshl_b32 s56, s31, 6
    s_add_u32 s52, s52, s56
    s_mul_i32 s15, s52, 2304
    s_mul_i32 s56, s30, 1152
    s_add_u32 s15, s15, s56
    s_lshr_b32 s56, s48, 2
    s_lshl_b32 s56, s56, 6
    s_add_u32 s15, s15, s56
    s_mov_b32 s52, s47
    s_mov_b32 s45, s14
    s_mov_b32 s44, 65536
    s_mov_b32 s46, 0x10000
L_pl:
    s_waitcnt lgkmcnt(0)
    s_lshl1_add_u32 s79, s79, s78
    s_lshl1_add_u32 s79, s79, s77
    s_lshl1_add_u32 s79, s79, s76
    s_lshl1_add_u32 s79, s79, s75
    s_lshl1_add_u32 s79, s79, s74
    s_lshl1_add_u32 s79, s79, s73
    s_lshl1_add_u32 s79, s79, s72
    s_mul_i32 s79, s79, 0x101
    s_lshr_b32 s79, s79, s48
    s_and_b32 s79, s79, 255
    s_cmp_eq_u32 s79, 255
    s_cbranch_scc1 L_pl_ok
    s_sub_u32 s46, s46, 1
    s_cbranch_scc1 L_pl_ok
    s_sleep 1
    s_load_dwordx8 s[72:79], s[16:17], s52 glc
    s_branch L_pl
L_pl_ok:
    buffer_load_dwordx4 v[80:83], v22, s[36:39], s44 offen sc1
    s_add_u32 s44, s44, 73728
    buffer_load_dwordx4 v[84:87], v22, s[36:39], s44 offen sc1
    s_add_u32 s44, s44, 73728
    buffer_load_dwordx4 v[88:91], v22, s[36:39], s44 offen sc1
    s_add_u32 s44, s44, 73728
    buffer_load_dwordx4 v[92:95], v22, s[36:39], s44 offen sc1
    s_add_u32 s44, s44, 73728
    buffer_load_dwordx4 v[96:99], v22, s[36:39], s44 offen sc1
    s_add_u32 s44, s44, 73728
    buffer_load_dwordx4 v[100:103], v22, s[36:39], s44 offen sc1
    s_add_u32 s44, s44, 73728
    buffer_load_dwordx4 v[104:107], v22, s[36:39], s44 offen sc1
    s_add_u32 s44, s44, 73728
    buffer_load_dwordx4 v[108:111], v22, s[36:39], s44 offen sc1
    s_waitcnt vmcnt(7)
    v_lshlrev_b32 v64, 16, v80
    v_and_b32 v65, 0xffff0000, v80
    v_lshlrev_b32 v66, 16, v81
    v_and_b32 v67, 0xffff0000, v81
    v_lshlrev_b32 v68, 16, v82
    v_and_b32 v69, 0xffff0000, v82
    v_lshlrev_b32 v70, 16, v83
    v_and_b32 v71, 0xffff0000, v83
    s_waitcnt vmcnt(6)
    v_lshlrev_b32 v60, 16, v84
    v_and_b32 v61, 0xffff0000, v84
    v_pk_add_f32 v[64:65], v[64:65], v[60:61]
    v_lshlrev_b32 v60, 16, v85
    v_and_b32 v61, 0xffff0000, v85
    v_pk_add_f32 v[66:67], v[66:67], v[60:61]
    v_lshlrev_b32 v60, 16, v86
    v_and_b32 v61, 0xffff0000, v86
    v_pk_add_f32 v[68:69], v[68:69], v[60:61]
    v_lshlrev_b32 v60, 16, v87
    v_and_b32 v61, 0xffff0000, v87
    v_pk_add_f32 v[70:71], v[70:71], v[60:61]
    s_waitcnt vmcnt(5)
    v_lshlrev_b32 v60, 16, v88
    v_and_b32 v61, 0xffff0000, v88
    v_pk_add_f32 v[64:65], v[64:65], v[60:61]
    v_lshlrev_b32 v60, 16, v89
    v_and_b32 v61, 0xffff0000, v89
    v_pk_add_f32 v[66:67], v[66:67], v[60:61]
    v_lshlrev_b32 v60, 16, v90
    v_and_b32 v61, 0xffff0000, v90
    v_pk_add_f32 v[68:69], v[68:69], v[60:61]
    v_lshlrev_b32 v60, 16, v91
    v_and_b32 v61, 0xffff0000, v91
    v_pk_add_f32 v[70:71], v[70:71], v[60:61]
    s_waitcnt vmcnt(4)
    v_lshlrev_b32 v60, 16, v92
    v_and_b32 v61, 0xffff0000, v92
    v_pk_add_f32 v[64:65], v[64:65], v[60:61]
    v_lshlrev_b32 v60, 16, v93
    v_and_b32 v61, 0xffff0000, v93
    v_pk_add_f32 v[66:67], v[66:67], v[60:61]
    v_lshlrev_b32 v60, 16, v94
    v_and_b32 v61, 0xffff0000, v94
    v_pk_add_f32 v[68:69], v[68:69], v[60:61]
    v_lshlrev_b32 v60, 16, v95
    v_and_b32 v61, 0xffff0000, v95
    v_pk_add_f32 v[70:71], v[70:71], v[60:61]
    s_waitcnt vmcnt(3)
    v_lshlrev_b32 v60, 16, v96
    v_and_b32 v61, 0xffff0000, v96
    v_pk_add_f32 v[64:65], v[64:65], v[60:61]
    v_lshlrev_b32 v60, 16, v97
    v_and_b32 v61, 0xffff0000, v97
    v_pk_add_f32 v[66:67], v[66:67], v[60:61]
    v_lshlrev_b32 v60, 16, v98
    v_and_b32 v61, 0xffff0000, v98
    v_pk_add_f32 v[68:69], v[68:69], v[60:61]
    v_lshlrev_b32 v60, 16, v99
    v_and_b32 v61, 0xffff0000, v99
    v_pk_add_f32 v[70:71], v[70:71], v[60:61]
    s_waitcnt vmcnt(2)
    v_lshlrev_b32 v60, 16, v100
    v_and_b32 v61, 0xffff0000, v100
    v_pk_add_f32 v[64:65], v[64:65], v[60:61]
    v_lshlrev_b32 v60, 16, v101
    v_and_b32 v61, 0xffff0000, v101
    v_pk_add_f32 v[66:67], v[66:67], v[60:61]
    v_lshlrev_b32 v60, 16, v102
    v_and_b32 v61, 0xffff0000, v102
    v_pk_add_f32 v[68:69], v[68:69], v[60:61]
    v_lshlrev_b32 v60, 16, v103
    v_and_b32 v61, 0xffff0000, v103
    v_pk_add_f32 v[70:71], v[70:71], v[60:61]
    s_waitcnt vmcnt(1)
    v_lshlrev_b32 v60, 16, v104
    v_and_b32 v61, 0xffff0000, v104
    v_pk_add_f32 v[64:65], v[64:65], v[60:61]
    v_lshlrev_b32 v60, 16, v105
    v_and_b32 v61, 0xffff0000, v105
    v_pk_add_f32 v[66:67], v[66:67], v[60:61]
    v_lshlrev_b32 v60, 16, v106
    v_and_b32 v61, 0xffff0000, v106
    v_pk_add_f32 v[68:69], v[68:69], v[60:61]
    v_lshlrev_b32 v60, 16, v107
    v_and_b32 v61, 0xffff0000, v107
    v_pk_add_f32 v[70:71], v[70:71], v[60:61]
    s_waitcnt vmcnt(0)
    v_lshlrev_b32 v60, 16, v108
    v_and_b32 v61, 0xffff0000, v108
    v_pk_add_f32 v[64:65], v[64:65], v[60:61]
    v_lshlrev_b32 v60, 16, v109
    v_and_b32 v61, 0xffff0000, v109
    v_pk_add_f32 v[66:67], v[66:67], v[60:61]
    v_lshlrev_b32 v60, 16, v110
    v_and_b32 v61, 0xffff0000, v110
    v_pk_add_f32 v[68:69], v[68:69], v[60:61]
    v_lshlrev_b32 v60, 16, v111
    v_and_b32 v61, 0xffff0000, v111
    v_pk_add_f32 v[70:71], v[70:71], v[60:61]
    v_cvt_pk_bf16_f32 v144, v64, v65
    v_cvt_pk_bf16_f32 v145, v66, v67
    v_cvt_pk_bf16_f32 v146, v68, v69
    v_cvt_pk_bf16_f32 v147, v70, v71
    ds_bpermute_b32 v144, v21, v144
    ds_bpermute_b32 v145, v21, v145
    ds_bpermute_b32 v146, v21, v146
    ds_bpermute_b32 v147, v21, v147
    s_lshl_b32 s57, s45, 7
    s_add_u32 s57, s57, s15
    s_waitcnt lgkmcnt(0)
    buffer_store_dwordx2 v[144:145], v23, s[40:43], s57 offen
    buffer_store_dwordx2 v[146:147], v23, s[40:43], s57 offen offset:32
L_end:
    s_endpgm

.section .rodata,"a"
.p2align 6
.amdhsa_kernel concat_heads__mha_block_cached__gqa_block_cached__near_ridge_kernel
  .amdhsa_next_free_vgpr 256
  .amdhsa_next_free_sgpr 102
  .amdhsa_accum_offset 256
  .amdhsa_group_segment_fixed_size 0
  .amdhsa_kernarg_size 104
  .amdhsa_user_sgpr_count 2
  .amdhsa_user_sgpr_kernarg_segment_ptr 1
  .amdhsa_system_sgpr_workgroup_id_x 1
  .amdhsa_float_denorm_mode_32 3
.end_amdhsa_kernel
```
